```python
import torch

def _softmax(x, axis=-1):
    return torch.softmax(x, dim=axis)
def _gelu(x):
    return torch.nn.functional.gelu(x, approximate="tanh")
def _silu(x):
    return torch.nn.functional.silu(x)
def _sigmoid(x):
    return torch.sigmoid(x)
def _layernorm(x, axis=-1, eps=1e-5):
    m = x.mean(dim=axis, keepdim=True)
    v = x.var(dim=axis, keepdim=True, unbiased=False)
    return (x - m) / torch.sqrt(v + eps)
def _scatter_add(tgt, idx, src, axis=0):
    return tgt.clone().index_add_(axis, idx, src)
def _segment_sum(src, seg, n):
    out = torch.zeros((n,) + src.shape[1:], dtype=src.dtype)
    return out.index_add_(0, seg, src)
def _pad(x, pw):
    flat = tuple(v for pair in reversed(pw) for v in pair)
    return torch.nn.functional.pad(x, flat)

kernel_name = 'concat_heads__sliding_local_dilated__mha_block__prompt'

def setup_inputs():

    _w = (lambda a: (lambda t: t.to(torch.bfloat16) if t.is_floating_point() else t)(torch.as_tensor(a)))
    def _A_setup():
        B, S, D = 1, 2048, 640
        return {
            "x": _w((lambda *s: torch.randn(*s, dtype=torch.bfloat16) * 0.4)(B, S, D)),
            "wqkv": _w((lambda *s: torch.randn(*s, dtype=torch.bfloat16) * 0.4)(D, 3 * D)),
            "wo": _w((lambda *s: torch.randn(*s, dtype=torch.bfloat16) * 0.05)(D, D)),
        }
    _A_in = _A_setup()

    def _B_setup():
        B, S, D, H = 1, 2048, 640, 32
        return {
            "x": _w((lambda *s: torch.randn(*s, dtype=torch.bfloat16) * 0.2)(B, S, D)),
            "wqkv": _w((lambda *s: torch.randn(*s, dtype=torch.bfloat16) * 0.4)(D, 3 * D)),
            "wo": _w((lambda *s: torch.randn(*s, dtype=torch.bfloat16) * 0.1)(D, D)),
        }
    _B_in = _B_setup()

    return {
        "A_x": _A_in["x"],
        "A_wqkv": _A_in["wqkv"],
        "A_wo": _A_in["wo"],
        "B_x": _B_in["x"],
        "B_wqkv": _B_in["wqkv"],
        "B_wo": _B_in["wo"],
    }

def reference(A_x, A_wqkv, A_wo, B_x, B_wqkv, B_wo):
    def _A_ref(x, wqkv, wo):
        B, S, D = x.shape
        H = 32; Dh = D // H
        W, dil = 8, 2
        qkv = (lambda x, *d: x.permute(*d))((x @ wqkv).reshape(B, S, 3, H, Dh), 2, 0, 3, 1, 4)
        q, k, v = qkv[0], qkv[1], qkv[2]
        scale = Dh ** -0.5
        pos = torch.arange(S)
        off = torch.arange(W) * dil
        idx = pos[:, None] - off[None, :]
        mask = idx >= 0
        idx_c = torch.where(mask, idx, 0).reshape(-1)
        kg = k[:, :, idx_c, :].reshape(B, H, S, W, Dh)
        vg = v[:, :, idx_c, :].reshape(B, H, S, W, Dh)
        logits = torch.einsum("bhsd,bhswd->bhsw", q, kg) * scale
        logits = torch.where(mask[None, None, :, :], logits, -1e9)
        attn = _softmax(logits, axis=-1)
        o = torch.einsum("bhsw,bhswd->bhsd", attn, vg)
        return (lambda x, *d: x.permute(*d))(o, 0, 2, 1, 3).reshape(B, S, D) @ wo

    def _B_ref(x, wqkv, wo):
        B, S, D = x.shape
        H = 32
        Dh = D // H
        qkv = (lambda x, *d: x.permute(*d))((x @ wqkv).reshape(B, S, 3, H, Dh), 2, 0, 3, 1, 4)
        q, k, v = qkv[0], qkv[1], qkv[2]
        scores = torch.einsum("bhqd,bhkd->bhqk", q, k) * (Dh ** -0.5)
        p = _softmax(scores, axis=-1)
        o = torch.einsum("bhqk,bhkd->bhqd", p, v)
        return (lambda x, *d: x.permute(*d))(o, 0, 2, 1, 3).reshape(B, S, D) @ wo

    a = _A_ref(A_x, A_wqkv, A_wo)
    b = _B_ref(B_x, B_wqkv, B_wo)
    return torch.concatenate([a, b], axis=-1)
```

```asm
; @launch kernel=qkv_kernel grid=(256,1,1) block=(512,1,1) lds=147456
; @launch kernel=attn_kernel grid=(256,1,1) block=(512,1,1) lds=140352
; @launch kernel=oproj_kernel grid=(256,1,1) block=(320,1,1) lds=143360
.amdgcn_target "amdgcn-amd-amdhsa--gfx950"
.text
.globl qkv_kernel
.p2align 8
.type qkv_kernel,@function
qkv_kernel:
    s_cmp_ge_u32 s2, 256
    s_cbranch_scc1 qkv_kernel_done2
    s_and_b32 s31, s2, 7
    s_lshr_b32 s32, s2, 3
    s_and_b32 s27, s31, 1
    s_bfe_u32 s25, s31, 0x10001
    s_lshl_b32 s25, s25, 2
    s_and_b32 s33, s32, 3
    s_add_u32 s25, s25, s33
    s_lshr_b32 s26, s31, 2
    s_lshl_b32 s26, s26, 3
    s_lshr_b32 s33, s32, 2
    s_add_u32 s26, s26, s33
    s_cmp_ge_u32 s26, 15
    s_cbranch_scc1 qkv_kernel_done2
    s_mul_i32 s42, s32, 3
    s_mul_i32 s33, s42, 6554
    s_lshr_b32 s33, s33, 16
    s_mul_i32 s33, s33, 10
    s_sub_u32 s42, s42, s33
    s_mov_b32 s42, 0
    s_load_dwordx4 s[4:7], s[0:1], 0
    s_load_dwordx4 s[8:11], s[0:1], 24
    s_load_dwordx2 s[36:37], s[0:1], 64
    s_waitcnt lgkmcnt(0)
    s_cmp_eq_u32 s27, 0
    s_cselect_b64 s[4:5], s[4:5], s[8:9]
    s_cselect_b64 s[6:7], s[6:7], s[10:11]
    s_mul_i32 s31, s25, 327680
    s_add_u32 s12, s4, s31
    s_addc_u32 s13, s5, 0
    s_mov_b32 s14, 327680
    s_mov_b32 s15, 0x00020000
    s_lshl_b32 s31, s26, 8
    s_add_u32 s16, s6, s31
    s_addc_u32 s17, s7, 0
    s_sub_u32 s18, 2457600, s31
    s_mov_b32 s19, 0x00020000
    s_mov_b32 s20, s36
    s_mov_b32 s21, s37
    s_mov_b32 s22, 33554432
    s_mov_b32 s23, 0x00020000
    v_lshrrev_b32 v1, 6, v0
    v_and_b32 v2, 63, v0
    s_nop 0
    v_readfirstlane_b32 s24, v1
    s_nop 3
    s_and_b32 s31, s24, 3
    s_mul_i32 s34, s31, 64
    s_lshr_b32 s31, s24, 2
    s_mul_i32 s35, s31, 64
    s_mul_i32 s28, s24, 4096
    s_mul_i32 s29, s24, 2048
    s_add_u32 s29, s29, 32768
    v_lshrrev_b32 v3, 3, v2
    s_mul_i32 s31, s24, 32
    v_add_u32 v3, s31, v3
    v_and_b32 v4, 7, v2
    s_mov_b32 s32, 1280
    v_add_u32 v5, 0, v3
    v_bfe_u32 v6, v5, 1, 3
    v_xor_b32 v6, v6, v4
    v_lshlrev_b32 v6, 4, v6
    v_mad_u32_u24 v8, v5, s32, v6
    v_add_u32 v5, 8, v3
    v_bfe_u32 v6, v5, 1, 3
    v_xor_b32 v6, v6, v4
    v_lshlrev_b32 v6, 4, v6
    v_mad_u32_u24 v9, v5, s32, v6
    v_add_u32 v5, 16, v3
    v_bfe_u32 v6, v5, 1, 3
    v_xor_b32 v6, v6, v4
    v_lshlrev_b32 v6, 4, v6
    v_mad_u32_u24 v10, v5, s32, v6
    v_add_u32 v5, 24, v3
    v_bfe_u32 v6, v5, 1, 3
    v_xor_b32 v6, v6, v4
    v_lshlrev_b32 v6, 4, v6
    v_mad_u32_u24 v11, v5, s32, v6
    v_lshrrev_b32 v3, 4, v2
    v_lshlrev_b32 v4, 2, v3
    v_and_b32 v5, 15, v2
    v_xor_b32 v4, v4, v5
    v_lshlrev_b32 v4, 4, v4
    s_mul_i32 s31, s24, 8
    v_add_u32 v3, s31, v3
    s_mov_b32 s32, 3840
    v_add_u32 v5, 0, v3
    v_mad_u32_u24 v12, v5, s32, v4
    v_add_u32 v5, 4, v3
    v_mad_u32_u24 v13, v5, s32, v4
    v_and_b32 v3, 31, v2
    v_add_u32 v3, s34, v3
    v_lshrrev_b32 v4, 5, v2
    v_bfe_u32 v5, v3, 1, 3
    v_lshlrev_b32 v3, 7, v3
    v_add_u32 v6, 0, v4
    v_xor_b32 v6, v6, v5
    v_lshl_add_u32 v14, v6, 4, v3
    v_add_u32 v18, 49152, v14
    v_add_u32 v22, 98304, v14
    v_add_u32 v6, 2, v4
    v_xor_b32 v6, v6, v5
    v_lshl_add_u32 v15, v6, 4, v3
    v_add_u32 v19, 49152, v15
    v_add_u32 v23, 98304, v15
    v_add_u32 v6, 4, v4
    v_xor_b32 v6, v6, v5
    v_lshl_add_u32 v16, v6, 4, v3
    v_add_u32 v20, 49152, v16
    v_add_u32 v24, 98304, v16
    v_add_u32 v6, 6, v4
    v_xor_b32 v6, v6, v5
    v_lshl_add_u32 v17, v6, 4, v3
    v_add_u32 v21, 49152, v17
    v_add_u32 v25, 98304, v17
    v_bfe_u32 v3, v2, 2, 2
    v_and_b32 v4, 3, v2
    v_bfe_u32 v5, v2, 4, 1
    v_lshrrev_b32 v6, 5, v2
    v_lshl_add_u32 v6, v6, 3, v3
    v_lshlrev_b32 v6, 8, v6
    v_and_b32 v7, 1, v4
    v_lshl_add_u32 v6, v7, 3, v6
    v_add_u32 v6, 32768, v6
    v_lshrrev_b32 v4, 1, v4
    v_lshl_add_u32 v4, v5, 1, v4
    s_lshr_b32 s31, s35, 3
    v_add_u32 v4, s31, v4
    v_lshlrev_b32 v3, 2, v3
    v_add_u32 v5, 0, v4
    v_xor_b32 v5, v5, v3
    v_lshl_add_u32 v26, v5, 4, v6
    v_add_u32 v28, 49152, v26
    v_add_u32 v30, 98304, v26
    v_add_u32 v5, 4, v4
    v_xor_b32 v5, v5, v3
    v_lshl_add_u32 v27, v5, 4, v6
    v_add_u32 v29, 49152, v27
    v_add_u32 v31, 98304, v27
    s_cmp_eq_u32 s27, 1
    s_cselect_b32 s31, s26, 0
    s_cmp_ge_u32 s31, 10
    s_cbranch_scc1 qkv_kernel_vtile
    v_mov_b32 v64, 0
    v_mov_b32 v65, 0
    v_mov_b32 v66, 0
    v_mov_b32 v67, 0
    v_mov_b32 v68, 0
    v_mov_b32 v69, 0
    v_mov_b32 v70, 0
    v_mov_b32 v71, 0
    v_mov_b32 v72, 0
    v_mov_b32 v73, 0
    v_mov_b32 v74, 0
    v_mov_b32 v75, 0
    v_mov_b32 v76, 0
    v_mov_b32 v77, 0
    v_mov_b32 v78, 0
    v_mov_b32 v79, 0
    v_mov_b32 v80, 0
    v_mov_b32 v81, 0
    v_mov_b32 v82, 0
    v_mov_b32 v83, 0
    v_mov_b32 v84, 0
    v_mov_b32 v85, 0
    v_mov_b32 v86, 0
    v_mov_b32 v87, 0
    v_mov_b32 v88, 0
    v_mov_b32 v89, 0
    v_mov_b32 v90, 0
    v_mov_b32 v91, 0
    v_mov_b32 v92, 0
    v_mov_b32 v93, 0
    v_mov_b32 v94, 0
    v_mov_b32 v95, 0
    v_mov_b32 v96, 0
    v_mov_b32 v97, 0
    v_mov_b32 v98, 0
    v_mov_b32 v99, 0
    v_mov_b32 v100, 0
    v_mov_b32 v101, 0
    v_mov_b32 v102, 0
    v_mov_b32 v103, 0
    v_mov_b32 v104, 0
    v_mov_b32 v105, 0
    v_mov_b32 v106, 0
    v_mov_b32 v107, 0
    v_mov_b32 v108, 0
    v_mov_b32 v109, 0
    v_mov_b32 v110, 0
    v_mov_b32 v111, 0
    v_mov_b32 v112, 0
    v_mov_b32 v113, 0
    v_mov_b32 v114, 0
    v_mov_b32 v115, 0
    v_mov_b32 v116, 0
    v_mov_b32 v117, 0
    v_mov_b32 v118, 0
    v_mov_b32 v119, 0
    v_mov_b32 v120, 0
    v_mov_b32 v121, 0
    v_mov_b32 v122, 0
    v_mov_b32 v123, 0
    v_mov_b32 v124, 0
    v_mov_b32 v125, 0
    v_mov_b32 v126, 0
    v_mov_b32 v127, 0
    s_lshl_b32 s30, s42, 7
    s_add_u32 m0, s28, 0
    s_nop 0
    buffer_load_dwordx4 v8, s[12:15], s30 offen lds
    s_add_u32 m0, s28, 1024
    s_nop 0
    buffer_load_dwordx4 v9, s[12:15], s30 offen lds
    s_add_u32 m0, s28, 2048
    s_nop 0
    buffer_load_dwordx4 v10, s[12:15], s30 offen lds
    s_add_u32 m0, s28, 3072
    s_nop 0
    buffer_load_dwordx4 v11, s[12:15], s30 offen lds
    s_mul_i32 s30, s42, 245760
    s_add_u32 m0, s29, 0
    s_nop 0
    buffer_load_dwordx4 v12, s[16:19], s30 offen lds
    s_add_u32 m0, s29, 1024
    s_nop 0
    buffer_load_dwordx4 v13, s[16:19], s30 offen lds
    s_add_u32 s42, s42, 1
    s_cmp_eq_u32 s42, 10
    s_cselect_b32 s42, 0, s42
    s_lshl_b32 s30, s42, 7
    s_add_u32 m0, s28, 49152
    s_nop 0
    buffer_load_dwordx4 v8, s[12:15], s30 offen lds
    s_add_u32 m0, s28, 50176
    s_nop 0
    buffer_load_dwordx4 v9, s[12:15], s30 offen lds
    s_add_u32 m0, s28, 51200
    s_nop 0
    buffer_load_dwordx4 v10, s[12:15], s30 offen lds
    s_add_u32 m0, s28, 52224
    s_nop 0
    buffer_load_dwordx4 v11, s[12:15], s30 offen lds
    s_mul_i32 s30, s42, 245760
    s_add_u32 m0, s29, 49152
    s_nop 0
    buffer_load_dwordx4 v12, s[16:19], s30 offen lds
    s_add_u32 m0, s29, 50176
    s_nop 0
    buffer_load_dwordx4 v13, s[16:19], s30 offen lds
    s_add_u32 s42, s42, 1
    s_cmp_eq_u32 s42, 10
    s_cselect_b32 s42, 0, s42
    s_waitcnt vmcnt(6)
    s_barrier
    ds_read_b128 v[32:35], v14 offset:0
    ds_read_b128 v[36:39], v14 offset:4096
    ds_read_b64_tr_b16 v[48:49], v26 offset:0
    ds_read_b64_tr_b16 v[50:51], v26 offset:1024
    ds_read_b64_tr_b16 v[52:53], v27 offset:0
    ds_read_b64_tr_b16 v[54:55], v27 offset:1024
    s_lshl_b32 s30, s42, 7
    s_add_u32 m0, s28, 98304
    s_nop 0
    buffer_load_dwordx4 v8, s[12:15], s30 offen lds
    s_add_u32 m0, s28, 99328
    s_nop 0
    buffer_load_dwordx4 v9, s[12:15], s30 offen lds
    s_add_u32 m0, s28, 100352
    s_nop 0
    buffer_load_dwordx4 v10, s[12:15], s30 offen lds
    s_add_u32 m0, s28, 101376
    s_nop 0
    buffer_load_dwordx4 v11, s[12:15], s30 offen lds
    s_mul_i32 s30, s42, 245760
    s_add_u32 m0, s29, 98304
    s_nop 0
    buffer_load_dwordx4 v12, s[16:19], s30 offen lds
    s_add_u32 m0, s29, 99328
    s_nop 0
    buffer_load_dwordx4 v13, s[16:19], s30 offen lds
    s_add_u32 s42, s42, 1
    s_cmp_eq_u32 s42, 10
    s_cselect_b32 s42, 0, s42
    ds_read_b128 v[40:43], v15 offset:0
    ds_read_b128 v[44:47], v15 offset:4096
    ds_read_b64_tr_b16 v[56:57], v26 offset:4096
    ds_read_b64_tr_b16 v[58:59], v26 offset:5120
    ds_read_b64_tr_b16 v[60:61], v27 offset:4096
    ds_read_b64_tr_b16 v[62:63], v27 offset:5120
    s_waitcnt lgkmcnt(6)
    v_mfma_f32_32x32x16_bf16 v[64:79], v[48:51], v[32:35], v[64:79]
    v_mfma_f32_32x32x16_bf16 v[80:95], v[52:55], v[32:35], v[80:95]
    v_mfma_f32_32x32x16_bf16 v[96:111], v[48:51], v[36:39], v[96:111]
    v_mfma_f32_32x32x16_bf16 v[112:127], v[52:55], v[36:39], v[112:127]
    ds_read_b128 v[32:35], v16 offset:0
    ds_read_b128 v[36:39], v16 offset:4096
    ds_read_b64_tr_b16 v[48:49], v26 offset:8192
    ds_read_b64_tr_b16 v[50:51], v26 offset:9216
    ds_read_b64_tr_b16 v[52:53], v27 offset:8192
    ds_read_b64_tr_b16 v[54:55], v27 offset:9216
    s_waitcnt lgkmcnt(6)
    v_mfma_f32_32x32x16_bf16 v[64:79], v[56:59], v[40:43], v[64:79]
    v_mfma_f32_32x32x16_bf16 v[80:95], v[60:63], v[40:43], v[80:95]
    v_mfma_f32_32x32x16_bf16 v[96:111], v[56:59], v[44:47], v[96:111]
    v_mfma_f32_32x32x16_bf16 v[112:127], v[60:63], v[44:47], v[112:127]
    ds_read_b128 v[40:43], v17 offset:0
    ds_read_b128 v[44:47], v17 offset:4096
    ds_read_b64_tr_b16 v[56:57], v26 offset:12288
    ds_read_b64_tr_b16 v[58:59], v26 offset:13312
    ds_read_b64_tr_b16 v[60:61], v27 offset:12288
    ds_read_b64_tr_b16 v[62:63], v27 offset:13312
    s_waitcnt lgkmcnt(6)
    v_mfma_f32_32x32x16_bf16 v[64:79], v[48:51], v[32:35], v[64:79]
    v_mfma_f32_32x32x16_bf16 v[80:95], v[52:55], v[32:35], v[80:95]
    v_mfma_f32_32x32x16_bf16 v[96:111], v[48:51], v[36:39], v[96:111]
    v_mfma_f32_32x32x16_bf16 v[112:127], v[52:55], v[36:39], v[112:127]
    s_waitcnt lgkmcnt(0)
    v_mfma_f32_32x32x16_bf16 v[64:79], v[56:59], v[40:43], v[64:79]
    v_mfma_f32_32x32x16_bf16 v[80:95], v[60:63], v[40:43], v[80:95]
    v_mfma_f32_32x32x16_bf16 v[96:111], v[56:59], v[44:47], v[96:111]
    v_mfma_f32_32x32x16_bf16 v[112:127], v[60:63], v[44:47], v[112:127]
    s_waitcnt vmcnt(6)
    s_barrier
    ds_read_b128 v[32:35], v18 offset:0
    ds_read_b128 v[36:39], v18 offset:4096
    ds_read_b64_tr_b16 v[48:49], v28 offset:0
    ds_read_b64_tr_b16 v[50:51], v28 offset:1024
    ds_read_b64_tr_b16 v[52:53], v29 offset:0
    ds_read_b64_tr_b16 v[54:55], v29 offset:1024
    s_lshl_b32 s30, s42, 7
    s_add_u32 m0, s28, 0
    s_nop 0
    buffer_load_dwordx4 v8, s[12:15], s30 offen lds
    s_add_u32 m0, s28, 1024
    s_nop 0
    buffer_load_dwordx4 v9, s[12:15], s30 offen lds
    s_add_u32 m0, s28, 2048
    s_nop 0
    buffer_load_dwordx4 v10, s[12:15], s30 offen lds
    s_add_u32 m0, s28, 3072
    s_nop 0
    buffer_load_dwordx4 v11, s[12:15], s30 offen lds
    s_mul_i32 s30, s42, 245760
    s_add_u32 m0, s29, 0
    s_nop 0
    buffer_load_dwordx4 v12, s[16:19], s30 offen lds
    s_add_u32 m0, s29, 1024
    s_nop 0
    buffer_load_dwordx4 v13, s[16:19], s30 offen lds
    s_add_u32 s42, s42, 1
    s_cmp_eq_u32 s42, 10
    s_cselect_b32 s42, 0, s42
    ds_read_b128 v[40:43], v19 offset:0
    ds_read_b128 v[44:47], v19 offset:4096
    ds_read_b64_tr_b16 v[56:57], v28 offset:4096
    ds_read_b64_tr_b16 v[58:59], v28 offset:5120
    ds_read_b64_tr_b16 v[60:61], v29 offset:4096
    ds_read_b64_tr_b16 v[62:63], v29 offset:5120
    s_waitcnt lgkmcnt(6)
    v_mfma_f32_32x32x16_bf16 v[64:79], v[48:51], v[32:35], v[64:79]
    v_mfma_f32_32x32x16_bf16 v[80:95], v[52:55], v[32:35], v[80:95]
    v_mfma_f32_32x32x16_bf16 v[96:111], v[48:51], v[36:39], v[96:111]
    v_mfma_f32_32x32x16_bf16 v[112:127], v[52:55], v[36:39], v[112:127]
    ds_read_b128 v[32:35], v20 offset:0
    ds_read_b128 v[36:39], v20 offset:4096
    ds_read_b64_tr_b16 v[48:49], v28 offset:8192
    ds_read_b64_tr_b16 v[50:51], v28 offset:9216
    ds_read_b64_tr_b16 v[52:53], v29 offset:8192
    ds_read_b64_tr_b16 v[54:55], v29 offset:9216
    s_waitcnt lgkmcnt(6)
    v_mfma_f32_32x32x16_bf16 v[64:79], v[56:59], v[40:43], v[64:79]
    v_mfma_f32_32x32x16_bf16 v[80:95], v[60:63], v[40:43], v[80:95]
    v_mfma_f32_32x32x16_bf16 v[96:111], v[56:59], v[44:47], v[96:111]
    v_mfma_f32_32x32x16_bf16 v[112:127], v[60:63], v[44:47], v[112:127]
    ds_read_b128 v[40:43], v21 offset:0
    ds_read_b128 v[44:47], v21 offset:4096
    ds_read_b64_tr_b16 v[56:57], v28 offset:12288
    ds_read_b64_tr_b16 v[58:59], v28 offset:13312
    ds_read_b64_tr_b16 v[60:61], v29 offset:12288
    ds_read_b64_tr_b16 v[62:63], v29 offset:13312
    s_waitcnt lgkmcnt(6)
    v_mfma_f32_32x32x16_bf16 v[64:79], v[48:51], v[32:35], v[64:79]
    v_mfma_f32_32x32x16_bf16 v[80:95], v[52:55], v[32:35], v[80:95]
    v_mfma_f32_32x32x16_bf16 v[96:111], v[48:51], v[36:39], v[96:111]
    v_mfma_f32_32x32x16_bf16 v[112:127], v[52:55], v[36:39], v[112:127]
    s_waitcnt lgkmcnt(0)
    v_mfma_f32_32x32x16_bf16 v[64:79], v[56:59], v[40:43], v[64:79]
    v_mfma_f32_32x32x16_bf16 v[80:95], v[60:63], v[40:43], v[80:95]
    v_mfma_f32_32x32x16_bf16 v[96:111], v[56:59], v[44:47], v[96:111]
    v_mfma_f32_32x32x16_bf16 v[112:127], v[60:63], v[44:47], v[112:127]
    s_waitcnt vmcnt(6)
    s_barrier
    ds_read_b128 v[32:35], v22 offset:0
    ds_read_b128 v[36:39], v22 offset:4096
    ds_read_b64_tr_b16 v[48:49], v30 offset:0
    ds_read_b64_tr_b16 v[50:51], v30 offset:1024
    ds_read_b64_tr_b16 v[52:53], v31 offset:0
    ds_read_b64_tr_b16 v[54:55], v31 offset:1024
    s_lshl_b32 s30, s42, 7
    s_add_u32 m0, s28, 49152
    s_nop 0
    buffer_load_dwordx4 v8, s[12:15], s30 offen lds
    s_add_u32 m0, s28, 50176
    s_nop 0
    buffer_load_dwordx4 v9, s[12:15], s30 offen lds
    s_add_u32 m0, s28, 51200
    s_nop 0
    buffer_load_dwordx4 v10, s[12:15], s30 offen lds
    s_add_u32 m0, s28, 52224
    s_nop 0
    buffer_load_dwordx4 v11, s[12:15], s30 offen lds
    s_mul_i32 s30, s42, 245760
    s_add_u32 m0, s29, 49152
    s_nop 0
    buffer_load_dwordx4 v12, s[16:19], s30 offen lds
    s_add_u32 m0, s29, 50176
    s_nop 0
    buffer_load_dwordx4 v13, s[16:19], s30 offen lds
    s_add_u32 s42, s42, 1
    s_cmp_eq_u32 s42, 10
    s_cselect_b32 s42, 0, s42
    ds_read_b128 v[40:43], v23 offset:0
    ds_read_b128 v[44:47], v23 offset:4096
    ds_read_b64_tr_b16 v[56:57], v30 offset:4096
    ds_read_b64_tr_b16 v[58:59], v30 offset:5120
    ds_read_b64_tr_b16 v[60:61], v31 offset:4096
    ds_read_b64_tr_b16 v[62:63], v31 offset:5120
    s_waitcnt lgkmcnt(6)
    v_mfma_f32_32x32x16_bf16 v[64:79], v[48:51], v[32:35], v[64:79]
    v_mfma_f32_32x32x16_bf16 v[80:95], v[52:55], v[32:35], v[80:95]
    v_mfma_f32_32x32x16_bf16 v[96:111], v[48:51], v[36:39], v[96:111]
    v_mfma_f32_32x32x16_bf16 v[112:127], v[52:55], v[36:39], v[112:127]
    ds_read_b128 v[32:35], v24 offset:0
    ds_read_b128 v[36:39], v24 offset:4096
    ds_read_b64_tr_b16 v[48:49], v30 offset:8192
    ds_read_b64_tr_b16 v[50:51], v30 offset:9216
    ds_read_b64_tr_b16 v[52:53], v31 offset:8192
    ds_read_b64_tr_b16 v[54:55], v31 offset:9216
    s_waitcnt lgkmcnt(6)
    v_mfma_f32_32x32x16_bf16 v[64:79], v[56:59], v[40:43], v[64:79]
    v_mfma_f32_32x32x16_bf16 v[80:95], v[60:63], v[40:43], v[80:95]
    v_mfma_f32_32x32x16_bf16 v[96:111], v[56:59], v[44:47], v[96:111]
    v_mfma_f32_32x32x16_bf16 v[112:127], v[60:63], v[44:47], v[112:127]
    ds_read_b128 v[40:43], v25 offset:0
    ds_read_b128 v[44:47], v25 offset:4096
    ds_read_b64_tr_b16 v[56:57], v30 offset:12288
    ds_read_b64_tr_b16 v[58:59], v30 offset:13312
    ds_read_b64_tr_b16 v[60:61], v31 offset:12288
    ds_read_b64_tr_b16 v[62:63], v31 offset:13312
    s_waitcnt lgkmcnt(6)
    v_mfma_f32_32x32x16_bf16 v[64:79], v[48:51], v[32:35], v[64:79]
    v_mfma_f32_32x32x16_bf16 v[80:95], v[52:55], v[32:35], v[80:95]
    v_mfma_f32_32x32x16_bf16 v[96:111], v[48:51], v[36:39], v[96:111]
    v_mfma_f32_32x32x16_bf16 v[112:127], v[52:55], v[36:39], v[112:127]
    s_waitcnt lgkmcnt(0)
    v_mfma_f32_32x32x16_bf16 v[64:79], v[56:59], v[40:43], v[64:79]
    v_mfma_f32_32x32x16_bf16 v[80:95], v[60:63], v[40:43], v[80:95]
    v_mfma_f32_32x32x16_bf16 v[96:111], v[56:59], v[44:47], v[96:111]
    v_mfma_f32_32x32x16_bf16 v[112:127], v[60:63], v[44:47], v[112:127]
    s_waitcnt vmcnt(6)
    s_barrier
    ds_read_b128 v[32:35], v14 offset:0
    ds_read_b128 v[36:39], v14 offset:4096
    ds_read_b64_tr_b16 v[48:49], v26 offset:0
    ds_read_b64_tr_b16 v[50:51], v26 offset:1024
    ds_read_b64_tr_b16 v[52:53], v27 offset:0
    ds_read_b64_tr_b16 v[54:55], v27 offset:1024
    s_lshl_b32 s30, s42, 7
    s_add_u32 m0, s28, 98304
    s_nop 0
    buffer_load_dwordx4 v8, s[12:15], s30 offen lds
    s_add_u32 m0, s28, 99328
    s_nop 0
    buffer_load_dwordx4 v9, s[12:15], s30 offen lds
    s_add_u32 m0, s28, 100352
    s_nop 0
    buffer_load_dwordx4 v10, s[12:15], s30 offen lds
    s_add_u32 m0, s28, 101376
    s_nop 0
    buffer_load_dwordx4 v11, s[12:15], s30 offen lds
    s_mul_i32 s30, s42, 245760
    s_add_u32 m0, s29, 98304
    s_nop 0
    buffer_load_dwordx4 v12, s[16:19], s30 offen lds
    s_add_u32 m0, s29, 99328
    s_nop 0
    buffer_load_dwordx4 v13, s[16:19], s30 offen lds
    s_add_u32 s42, s42, 1
    s_cmp_eq_u32 s42, 10
    s_cselect_b32 s42, 0, s42
    ds_read_b128 v[40:43], v15 offset:0
    ds_read_b128 v[44:47], v15 offset:4096
    ds_read_b64_tr_b16 v[56:57], v26 offset:4096
    ds_read_b64_tr_b16 v[58:59], v26 offset:5120
    ds_read_b64_tr_b16 v[60:61], v27 offset:4096
    ds_read_b64_tr_b16 v[62:63], v27 offset:5120
    s_waitcnt lgkmcnt(6)
    v_mfma_f32_32x32x16_bf16 v[64:79], v[48:51], v[32:35], v[64:79]
    v_mfma_f32_32x32x16_bf16 v[80:95], v[52:55], v[32:35], v[80:95]
    v_mfma_f32_32x32x16_bf16 v[96:111], v[48:51], v[36:39], v[96:111]
    v_mfma_f32_32x32x16_bf16 v[112:127], v[52:55], v[36:39], v[112:127]
    ds_read_b128 v[32:35], v16 offset:0
    ds_read_b128 v[36:39], v16 offset:4096
    ds_read_b64_tr_b16 v[48:49], v26 offset:8192
    ds_read_b64_tr_b16 v[50:51], v26 offset:9216
    ds_read_b64_tr_b16 v[52:53], v27 offset:8192
    ds_read_b64_tr_b16 v[54:55], v27 offset:9216
    s_waitcnt lgkmcnt(6)
    v_mfma_f32_32x32x16_bf16 v[64:79], v[56:59], v[40:43], v[64:79]
    v_mfma_f32_32x32x16_bf16 v[80:95], v[60:63], v[40:43], v[80:95]
    v_mfma_f32_32x32x16_bf16 v[96:111], v[56:59], v[44:47], v[96:111]
    v_mfma_f32_32x32x16_bf16 v[112:127], v[60:63], v[44:47], v[112:127]
    ds_read_b128 v[40:43], v17 offset:0
    ds_read_b128 v[44:47], v17 offset:4096
    ds_read_b64_tr_b16 v[56:57], v26 offset:12288
    ds_read_b64_tr_b16 v[58:59], v26 offset:13312
    ds_read_b64_tr_b16 v[60:61], v27 offset:12288
    ds_read_b64_tr_b16 v[62:63], v27 offset:13312
    s_waitcnt lgkmcnt(6)
    v_mfma_f32_32x32x16_bf16 v[64:79], v[48:51], v[32:35], v[64:79]
    v_mfma_f32_32x32x16_bf16 v[80:95], v[52:55], v[32:35], v[80:95]
    v_mfma_f32_32x32x16_bf16 v[96:111], v[48:51], v[36:39], v[96:111]
    v_mfma_f32_32x32x16_bf16 v[112:127], v[52:55], v[36:39], v[112:127]
    s_waitcnt lgkmcnt(0)
    v_mfma_f32_32x32x16_bf16 v[64:79], v[56:59], v[40:43], v[64:79]
    v_mfma_f32_32x32x16_bf16 v[80:95], v[60:63], v[40:43], v[80:95]
    v_mfma_f32_32x32x16_bf16 v[96:111], v[56:59], v[44:47], v[96:111]
    v_mfma_f32_32x32x16_bf16 v[112:127], v[60:63], v[44:47], v[112:127]
    s_waitcnt vmcnt(6)
    s_barrier
    ds_read_b128 v[32:35], v18 offset:0
    ds_read_b128 v[36:39], v18 offset:4096
    ds_read_b64_tr_b16 v[48:49], v28 offset:0
    ds_read_b64_tr_b16 v[50:51], v28 offset:1024
    ds_read_b64_tr_b16 v[52:53], v29 offset:0
    ds_read_b64_tr_b16 v[54:55], v29 offset:1024
    s_lshl_b32 s30, s42, 7
    s_add_u32 m0, s28, 0
    s_nop 0
    buffer_load_dwordx4 v8, s[12:15], s30 offen lds
    s_add_u32 m0, s28, 1024
    s_nop 0
    buffer_load_dwordx4 v9, s[12:15], s30 offen lds
    s_add_u32 m0, s28, 2048
    s_nop 0
    buffer_load_dwordx4 v10, s[12:15], s30 offen lds
    s_add_u32 m0, s28, 3072
    s_nop 0
    buffer_load_dwordx4 v11, s[12:15], s30 offen lds
    s_mul_i32 s30, s42, 245760
    s_add_u32 m0, s29, 0
    s_nop 0
    buffer_load_dwordx4 v12, s[16:19], s30 offen lds
    s_add_u32 m0, s29, 1024
    s_nop 0
    buffer_load_dwordx4 v13, s[16:19], s30 offen lds
    s_add_u32 s42, s42, 1
    s_cmp_eq_u32 s42, 10
    s_cselect_b32 s42, 0, s42
    ds_read_b128 v[40:43], v19 offset:0
    ds_read_b128 v[44:47], v19 offset:4096
    ds_read_b64_tr_b16 v[56:57], v28 offset:4096
    ds_read_b64_tr_b16 v[58:59], v28 offset:5120
    ds_read_b64_tr_b16 v[60:61], v29 offset:4096
    ds_read_b64_tr_b16 v[62:63], v29 offset:5120
    s_waitcnt lgkmcnt(6)
    v_mfma_f32_32x32x16_bf16 v[64:79], v[48:51], v[32:35], v[64:79]
    v_mfma_f32_32x32x16_bf16 v[80:95], v[52:55], v[32:35], v[80:95]
    v_mfma_f32_32x32x16_bf16 v[96:111], v[48:51], v[36:39], v[96:111]
    v_mfma_f32_32x32x16_bf16 v[112:127], v[52:55], v[36:39], v[112:127]
    ds_read_b128 v[32:35], v20 offset:0
    ds_read_b128 v[36:39], v20 offset:4096
    ds_read_b64_tr_b16 v[48:49], v28 offset:8192
    ds_read_b64_tr_b16 v[50:51], v28 offset:9216
    ds_read_b64_tr_b16 v[52:53], v29 offset:8192
    ds_read_b64_tr_b16 v[54:55], v29 offset:9216
    s_waitcnt lgkmcnt(6)
    v_mfma_f32_32x32x16_bf16 v[64:79], v[56:59], v[40:43], v[64:79]
    v_mfma_f32_32x32x16_bf16 v[80:95], v[60:63], v[40:43], v[80:95]
    v_mfma_f32_32x32x16_bf16 v[96:111], v[56:59], v[44:47], v[96:111]
    v_mfma_f32_32x32x16_bf16 v[112:127], v[60:63], v[44:47], v[112:127]
    ds_read_b128 v[40:43], v21 offset:0
    ds_read_b128 v[44:47], v21 offset:4096
    ds_read_b64_tr_b16 v[56:57], v28 offset:12288
    ds_read_b64_tr_b16 v[58:59], v28 offset:13312
    ds_read_b64_tr_b16 v[60:61], v29 offset:12288
    ds_read_b64_tr_b16 v[62:63], v29 offset:13312
    s_waitcnt lgkmcnt(6)
    v_mfma_f32_32x32x16_bf16 v[64:79], v[48:51], v[32:35], v[64:79]
    v_mfma_f32_32x32x16_bf16 v[80:95], v[52:55], v[32:35], v[80:95]
    v_mfma_f32_32x32x16_bf16 v[96:111], v[48:51], v[36:39], v[96:111]
    v_mfma_f32_32x32x16_bf16 v[112:127], v[52:55], v[36:39], v[112:127]
    s_waitcnt lgkmcnt(0)
    v_mfma_f32_32x32x16_bf16 v[64:79], v[56:59], v[40:43], v[64:79]
    v_mfma_f32_32x32x16_bf16 v[80:95], v[60:63], v[40:43], v[80:95]
    v_mfma_f32_32x32x16_bf16 v[96:111], v[56:59], v[44:47], v[96:111]
    v_mfma_f32_32x32x16_bf16 v[112:127], v[60:63], v[44:47], v[112:127]
    s_waitcnt vmcnt(6)
    s_barrier
    ds_read_b128 v[32:35], v22 offset:0
    ds_read_b128 v[36:39], v22 offset:4096
    ds_read_b64_tr_b16 v[48:49], v30 offset:0
    ds_read_b64_tr_b16 v[50:51], v30 offset:1024
    ds_read_b64_tr_b16 v[52:53], v31 offset:0
    ds_read_b64_tr_b16 v[54:55], v31 offset:1024
    s_lshl_b32 s30, s42, 7
    s_add_u32 m0, s28, 49152
    s_nop 0
    buffer_load_dwordx4 v8, s[12:15], s30 offen lds
    s_add_u32 m0, s28, 50176
    s_nop 0
    buffer_load_dwordx4 v9, s[12:15], s30 offen lds
    s_add_u32 m0, s28, 51200
    s_nop 0
    buffer_load_dwordx4 v10, s[12:15], s30 offen lds
    s_add_u32 m0, s28, 52224
    s_nop 0
    buffer_load_dwordx4 v11, s[12:15], s30 offen lds
    s_mul_i32 s30, s42, 245760
    s_add_u32 m0, s29, 49152
    s_nop 0
    buffer_load_dwordx4 v12, s[16:19], s30 offen lds
    s_add_u32 m0, s29, 50176
    s_nop 0
    buffer_load_dwordx4 v13, s[16:19], s30 offen lds
    s_add_u32 s42, s42, 1
    s_cmp_eq_u32 s42, 10
    s_cselect_b32 s42, 0, s42
    ds_read_b128 v[40:43], v23 offset:0
    ds_read_b128 v[44:47], v23 offset:4096
    ds_read_b64_tr_b16 v[56:57], v30 offset:4096
    ds_read_b64_tr_b16 v[58:59], v30 offset:5120
    ds_read_b64_tr_b16 v[60:61], v31 offset:4096
    ds_read_b64_tr_b16 v[62:63], v31 offset:5120
    s_waitcnt lgkmcnt(6)
    v_mfma_f32_32x32x16_bf16 v[64:79], v[48:51], v[32:35], v[64:79]
    v_mfma_f32_32x32x16_bf16 v[80:95], v[52:55], v[32:35], v[80:95]
    v_mfma_f32_32x32x16_bf16 v[96:111], v[48:51], v[36:39], v[96:111]
    v_mfma_f32_32x32x16_bf16 v[112:127], v[52:55], v[36:39], v[112:127]
    ds_read_b128 v[32:35], v24 offset:0
    ds_read_b128 v[36:39], v24 offset:4096
    ds_read_b64_tr_b16 v[48:49], v30 offset:8192
    ds_read_b64_tr_b16 v[50:51], v30 offset:9216
    ds_read_b64_tr_b16 v[52:53], v31 offset:8192
    ds_read_b64_tr_b16 v[54:55], v31 offset:9216
    s_waitcnt lgkmcnt(6)
    v_mfma_f32_32x32x16_bf16 v[64:79], v[56:59], v[40:43], v[64:79]
    v_mfma_f32_32x32x16_bf16 v[80:95], v[60:63], v[40:43], v[80:95]
    v_mfma_f32_32x32x16_bf16 v[96:111], v[56:59], v[44:47], v[96:111]
    v_mfma_f32_32x32x16_bf16 v[112:127], v[60:63], v[44:47], v[112:127]
    ds_read_b128 v[40:43], v25 offset:0
    ds_read_b128 v[44:47], v25 offset:4096
    ds_read_b64_tr_b16 v[56:57], v30 offset:12288
    ds_read_b64_tr_b16 v[58:59], v30 offset:13312
    ds_read_b64_tr_b16 v[60:61], v31 offset:12288
    ds_read_b64_tr_b16 v[62:63], v31 offset:13312
    s_waitcnt lgkmcnt(6)
    v_mfma_f32_32x32x16_bf16 v[64:79], v[48:51], v[32:35], v[64:79]
    v_mfma_f32_32x32x16_bf16 v[80:95], v[52:55], v[32:35], v[80:95]
    v_mfma_f32_32x32x16_bf16 v[96:111], v[48:51], v[36:39], v[96:111]
    v_mfma_f32_32x32x16_bf16 v[112:127], v[52:55], v[36:39], v[112:127]
    s_waitcnt lgkmcnt(0)
    v_mfma_f32_32x32x16_bf16 v[64:79], v[56:59], v[40:43], v[64:79]
    v_mfma_f32_32x32x16_bf16 v[80:95], v[60:63], v[40:43], v[80:95]
    v_mfma_f32_32x32x16_bf16 v[96:111], v[56:59], v[44:47], v[96:111]
    v_mfma_f32_32x32x16_bf16 v[112:127], v[60:63], v[44:47], v[112:127]
    s_waitcnt vmcnt(6)
    s_barrier
    ds_read_b128 v[32:35], v14 offset:0
    ds_read_b128 v[36:39], v14 offset:4096
    ds_read_b64_tr_b16 v[48:49], v26 offset:0
    ds_read_b64_tr_b16 v[50:51], v26 offset:1024
    ds_read_b64_tr_b16 v[52:53], v27 offset:0
    ds_read_b64_tr_b16 v[54:55], v27 offset:1024
    s_lshl_b32 s30, s42, 7
    s_add_u32 m0, s28, 98304
    s_nop 0
    buffer_load_dwordx4 v8, s[12:15], s30 offen lds
    s_add_u32 m0, s28, 99328
    s_nop 0
    buffer_load_dwordx4 v9, s[12:15], s30 offen lds
    s_add_u32 m0, s28, 100352
    s_nop 0
    buffer_load_dwordx4 v10, s[12:15], s30 offen lds
    s_add_u32 m0, s28, 101376
    s_nop 0
    buffer_load_dwordx4 v11, s[12:15], s30 offen lds
    s_mul_i32 s30, s42, 245760
    s_add_u32 m0, s29, 98304
    s_nop 0
    buffer_load_dwordx4 v12, s[16:19], s30 offen lds
    s_add_u32 m0, s29, 99328
    s_nop 0
    buffer_load_dwordx4 v13, s[16:19], s30 offen lds
    s_add_u32 s42, s42, 1
    s_cmp_eq_u32 s42, 10
    s_cselect_b32 s42, 0, s42
    ds_read_b128 v[40:43], v15 offset:0
    ds_read_b128 v[44:47], v15 offset:4096
    ds_read_b64_tr_b16 v[56:57], v26 offset:4096
    ds_read_b64_tr_b16 v[58:59], v26 offset:5120
    ds_read_b64_tr_b16 v[60:61], v27 offset:4096
    ds_read_b64_tr_b16 v[62:63], v27 offset:5120
    s_waitcnt lgkmcnt(6)
    v_mfma_f32_32x32x16_bf16 v[64:79], v[48:51], v[32:35], v[64:79]
    v_mfma_f32_32x32x16_bf16 v[80:95], v[52:55], v[32:35], v[80:95]
    v_mfma_f32_32x32x16_bf16 v[96:111], v[48:51], v[36:39], v[96:111]
    v_mfma_f32_32x32x16_bf16 v[112:127], v[52:55], v[36:39], v[112:127]
    ds_read_b128 v[32:35], v16 offset:0
    ds_read_b128 v[36:39], v16 offset:4096
    ds_read_b64_tr_b16 v[48:49], v26 offset:8192
    ds_read_b64_tr_b16 v[50:51], v26 offset:9216
    ds_read_b64_tr_b16 v[52:53], v27 offset:8192
    ds_read_b64_tr_b16 v[54:55], v27 offset:9216
    s_waitcnt lgkmcnt(6)
    v_mfma_f32_32x32x16_bf16 v[64:79], v[56:59], v[40:43], v[64:79]
    v_mfma_f32_32x32x16_bf16 v[80:95], v[60:63], v[40:43], v[80:95]
    v_mfma_f32_32x32x16_bf16 v[96:111], v[56:59], v[44:47], v[96:111]
    v_mfma_f32_32x32x16_bf16 v[112:127], v[60:63], v[44:47], v[112:127]
    ds_read_b128 v[40:43], v17 offset:0
    ds_read_b128 v[44:47], v17 offset:4096
    ds_read_b64_tr_b16 v[56:57], v26 offset:12288
    ds_read_b64_tr_b16 v[58:59], v26 offset:13312
    ds_read_b64_tr_b16 v[60:61], v27 offset:12288
    ds_read_b64_tr_b16 v[62:63], v27 offset:13312
    s_waitcnt lgkmcnt(6)
    v_mfma_f32_32x32x16_bf16 v[64:79], v[48:51], v[32:35], v[64:79]
    v_mfma_f32_32x32x16_bf16 v[80:95], v[52:55], v[32:35], v[80:95]
    v_mfma_f32_32x32x16_bf16 v[96:111], v[48:51], v[36:39], v[96:111]
    v_mfma_f32_32x32x16_bf16 v[112:127], v[52:55], v[36:39], v[112:127]
    s_waitcnt lgkmcnt(0)
    v_mfma_f32_32x32x16_bf16 v[64:79], v[56:59], v[40:43], v[64:79]
    v_mfma_f32_32x32x16_bf16 v[80:95], v[60:63], v[40:43], v[80:95]
    v_mfma_f32_32x32x16_bf16 v[96:111], v[56:59], v[44:47], v[96:111]
    v_mfma_f32_32x32x16_bf16 v[112:127], v[60:63], v[44:47], v[112:127]
    s_waitcnt vmcnt(6)
    s_barrier
    ds_read_b128 v[32:35], v18 offset:0
    ds_read_b128 v[36:39], v18 offset:4096
    ds_read_b64_tr_b16 v[48:49], v28 offset:0
    ds_read_b64_tr_b16 v[50:51], v28 offset:1024
    ds_read_b64_tr_b16 v[52:53], v29 offset:0
    ds_read_b64_tr_b16 v[54:55], v29 offset:1024
    s_lshl_b32 s30, s42, 7
    s_add_u32 m0, s28, 0
    s_nop 0
    buffer_load_dwordx4 v8, s[12:15], s30 offen lds
    s_add_u32 m0, s28, 1024
    s_nop 0
    buffer_load_dwordx4 v9, s[12:15], s30 offen lds
    s_add_u32 m0, s28, 2048
    s_nop 0
    buffer_load_dwordx4 v10, s[12:15], s30 offen lds
    s_add_u32 m0, s28, 3072
    s_nop 0
    buffer_load_dwordx4 v11, s[12:15], s30 offen lds
    s_mul_i32 s30, s42, 245760
    s_add_u32 m0, s29, 0
    s_nop 0
    buffer_load_dwordx4 v12, s[16:19], s30 offen lds
    s_add_u32 m0, s29, 1024
    s_nop 0
    buffer_load_dwordx4 v13, s[16:19], s30 offen lds
    s_add_u32 s42, s42, 1
    s_cmp_eq_u32 s42, 10
    s_cselect_b32 s42, 0, s42
    ds_read_b128 v[40:43], v19 offset:0
    ds_read_b128 v[44:47], v19 offset:4096
    ds_read_b64_tr_b16 v[56:57], v28 offset:4096
    ds_read_b64_tr_b16 v[58:59], v28 offset:5120
    ds_read_b64_tr_b16 v[60:61], v29 offset:4096
    ds_read_b64_tr_b16 v[62:63], v29 offset:5120
    s_waitcnt lgkmcnt(6)
    v_mfma_f32_32x32x16_bf16 v[64:79], v[48:51], v[32:35], v[64:79]
    v_mfma_f32_32x32x16_bf16 v[80:95], v[52:55], v[32:35], v[80:95]
    v_mfma_f32_32x32x16_bf16 v[96:111], v[48:51], v[36:39], v[96:111]
    v_mfma_f32_32x32x16_bf16 v[112:127], v[52:55], v[36:39], v[112:127]
    ds_read_b128 v[32:35], v20 offset:0
    ds_read_b128 v[36:39], v20 offset:4096
    ds_read_b64_tr_b16 v[48:49], v28 offset:8192
    ds_read_b64_tr_b16 v[50:51], v28 offset:9216
    ds_read_b64_tr_b16 v[52:53], v29 offset:8192
    ds_read_b64_tr_b16 v[54:55], v29 offset:9216
    s_waitcnt lgkmcnt(6)
    v_mfma_f32_32x32x16_bf16 v[64:79], v[56:59], v[40:43], v[64:79]
    v_mfma_f32_32x32x16_bf16 v[80:95], v[60:63], v[40:43], v[80:95]
    v_mfma_f32_32x32x16_bf16 v[96:111], v[56:59], v[44:47], v[96:111]
    v_mfma_f32_32x32x16_bf16 v[112:127], v[60:63], v[44:47], v[112:127]
    ds_read_b128 v[40:43], v21 offset:0
    ds_read_b128 v[44:47], v21 offset:4096
    ds_read_b64_tr_b16 v[56:57], v28 offset:12288
    ds_read_b64_tr_b16 v[58:59], v28 offset:13312
    ds_read_b64_tr_b16 v[60:61], v29 offset:12288
    ds_read_b64_tr_b16 v[62:63], v29 offset:13312
    s_waitcnt lgkmcnt(6)
    v_mfma_f32_32x32x16_bf16 v[64:79], v[48:51], v[32:35], v[64:79]
    v_mfma_f32_32x32x16_bf16 v[80:95], v[52:55], v[32:35], v[80:95]
    v_mfma_f32_32x32x16_bf16 v[96:111], v[48:51], v[36:39], v[96:111]
    v_mfma_f32_32x32x16_bf16 v[112:127], v[52:55], v[36:39], v[112:127]
    s_waitcnt lgkmcnt(0)
    v_mfma_f32_32x32x16_bf16 v[64:79], v[56:59], v[40:43], v[64:79]
    v_mfma_f32_32x32x16_bf16 v[80:95], v[60:63], v[40:43], v[80:95]
    v_mfma_f32_32x32x16_bf16 v[96:111], v[56:59], v[44:47], v[96:111]
    v_mfma_f32_32x32x16_bf16 v[112:127], v[60:63], v[44:47], v[112:127]
    s_waitcnt vmcnt(6)
    s_barrier
    ds_read_b128 v[32:35], v22 offset:0
    ds_read_b128 v[36:39], v22 offset:4096
    ds_read_b64_tr_b16 v[48:49], v30 offset:0
    ds_read_b64_tr_b16 v[50:51], v30 offset:1024
    ds_read_b64_tr_b16 v[52:53], v31 offset:0
    ds_read_b64_tr_b16 v[54:55], v31 offset:1024
    ds_read_b128 v[40:43], v23 offset:0
    ds_read_b128 v[44:47], v23 offset:4096
    ds_read_b64_tr_b16 v[56:57], v30 offset:4096
    ds_read_b64_tr_b16 v[58:59], v30 offset:5120
    ds_read_b64_tr_b16 v[60:61], v31 offset:4096
    ds_read_b64_tr_b16 v[62:63], v31 offset:5120
    s_waitcnt lgkmcnt(6)
    v_mfma_f32_32x32x16_bf16 v[64:79], v[48:51], v[32:35], v[64:79]
    v_mfma_f32_32x32x16_bf16 v[80:95], v[52:55], v[32:35], v[80:95]
    v_mfma_f32_32x32x16_bf16 v[96:111], v[48:51], v[36:39], v[96:111]
    v_mfma_f32_32x32x16_bf16 v[112:127], v[52:55], v[36:39], v[112:127]
    ds_read_b128 v[32:35], v24 offset:0
    ds_read_b128 v[36:39], v24 offset:4096
    ds_read_b64_tr_b16 v[48:49], v30 offset:8192
    ds_read_b64_tr_b16 v[50:51], v30 offset:9216
    ds_read_b64_tr_b16 v[52:53], v31 offset:8192
    ds_read_b64_tr_b16 v[54:55], v31 offset:9216
    s_waitcnt lgkmcnt(6)
    v_mfma_f32_32x32x16_bf16 v[64:79], v[56:59], v[40:43], v[64:79]
    v_mfma_f32_32x32x16_bf16 v[80:95], v[60:63], v[40:43], v[80:95]
    v_mfma_f32_32x32x16_bf16 v[96:111], v[56:59], v[44:47], v[96:111]
    v_mfma_f32_32x32x16_bf16 v[112:127], v[60:63], v[44:47], v[112:127]
    ds_read_b128 v[40:43], v25 offset:0
    ds_read_b128 v[44:47], v25 offset:4096
    ds_read_b64_tr_b16 v[56:57], v30 offset:12288
    ds_read_b64_tr_b16 v[58:59], v30 offset:13312
    ds_read_b64_tr_b16 v[60:61], v31 offset:12288
    ds_read_b64_tr_b16 v[62:63], v31 offset:13312
    s_waitcnt lgkmcnt(6)
    v_mfma_f32_32x32x16_bf16 v[64:79], v[48:51], v[32:35], v[64:79]
    v_mfma_f32_32x32x16_bf16 v[80:95], v[52:55], v[32:35], v[80:95]
    v_mfma_f32_32x32x16_bf16 v[96:111], v[48:51], v[36:39], v[96:111]
    v_mfma_f32_32x32x16_bf16 v[112:127], v[52:55], v[36:39], v[112:127]
    s_waitcnt lgkmcnt(0)
    v_mfma_f32_32x32x16_bf16 v[64:79], v[56:59], v[40:43], v[64:79]
    v_mfma_f32_32x32x16_bf16 v[80:95], v[60:63], v[40:43], v[80:95]
    v_mfma_f32_32x32x16_bf16 v[96:111], v[56:59], v[44:47], v[96:111]
    v_mfma_f32_32x32x16_bf16 v[112:127], v[60:63], v[44:47], v[112:127]
    s_waitcnt vmcnt(0)
    s_barrier
    ds_read_b128 v[32:35], v14 offset:0
    ds_read_b128 v[36:39], v14 offset:4096
    ds_read_b64_tr_b16 v[48:49], v26 offset:0
    ds_read_b64_tr_b16 v[50:51], v26 offset:1024
    ds_read_b64_tr_b16 v[52:53], v27 offset:0
    ds_read_b64_tr_b16 v[54:55], v27 offset:1024
    ds_read_b128 v[40:43], v15 offset:0
    ds_read_b128 v[44:47], v15 offset:4096
    ds_read_b64_tr_b16 v[56:57], v26 offset:4096
    ds_read_b64_tr_b16 v[58:59], v26 offset:5120
    ds_read_b64_tr_b16 v[60:61], v27 offset:4096
    ds_read_b64_tr_b16 v[62:63], v27 offset:5120
    s_waitcnt lgkmcnt(6)
    v_mfma_f32_32x32x16_bf16 v[64:79], v[48:51], v[32:35], v[64:79]
    v_mfma_f32_32x32x16_bf16 v[80:95], v[52:55], v[32:35], v[80:95]
    v_mfma_f32_32x32x16_bf16 v[96:111], v[48:51], v[36:39], v[96:111]
    v_mfma_f32_32x32x16_bf16 v[112:127], v[52:55], v[36:39], v[112:127]
    ds_read_b128 v[32:35], v16 offset:0
    ds_read_b128 v[36:39], v16 offset:4096
    ds_read_b64_tr_b16 v[48:49], v26 offset:8192
    ds_read_b64_tr_b16 v[50:51], v26 offset:9216
    ds_read_b64_tr_b16 v[52:53], v27 offset:8192
    ds_read_b64_tr_b16 v[54:55], v27 offset:9216
    s_waitcnt lgkmcnt(6)
    v_mfma_f32_32x32x16_bf16 v[64:79], v[56:59], v[40:43], v[64:79]
    v_mfma_f32_32x32x16_bf16 v[80:95], v[60:63], v[40:43], v[80:95]
    v_mfma_f32_32x32x16_bf16 v[96:111], v[56:59], v[44:47], v[96:111]
    v_mfma_f32_32x32x16_bf16 v[112:127], v[60:63], v[44:47], v[112:127]
    ds_read_b128 v[40:43], v17 offset:0
    ds_read_b128 v[44:47], v17 offset:4096
    ds_read_b64_tr_b16 v[56:57], v26 offset:12288
    ds_read_b64_tr_b16 v[58:59], v26 offset:13312
    ds_read_b64_tr_b16 v[60:61], v27 offset:12288
    ds_read_b64_tr_b16 v[62:63], v27 offset:13312
    s_waitcnt lgkmcnt(6)
    v_mfma_f32_32x32x16_bf16 v[64:79], v[48:51], v[32:35], v[64:79]
    v_mfma_f32_32x32x16_bf16 v[80:95], v[52:55], v[32:35], v[80:95]
    v_mfma_f32_32x32x16_bf16 v[96:111], v[48:51], v[36:39], v[96:111]
    v_mfma_f32_32x32x16_bf16 v[112:127], v[52:55], v[36:39], v[112:127]
    s_waitcnt lgkmcnt(0)
    v_mfma_f32_32x32x16_bf16 v[64:79], v[56:59], v[40:43], v[64:79]
    v_mfma_f32_32x32x16_bf16 v[80:95], v[60:63], v[40:43], v[80:95]
    v_mfma_f32_32x32x16_bf16 v[96:111], v[56:59], v[44:47], v[96:111]
    v_mfma_f32_32x32x16_bf16 v[112:127], v[60:63], v[44:47], v[112:127]
    s_nop 15
    s_nop 15
    v_and_b32 v2, 63, v0
    v_and_b32 v3, 31, v2
    v_lshrrev_b32 v4, 5, v2
    v_lshlrev_b32 v4, 2, v4
    s_lshl_b32 s31, s26, 7
    s_add_u32 s31, s31, s35
    v_add_u32 v4, s31, v4
    s_lshl_b32 s32, s25, 8
    s_add_u32 s32, s32, s34
    v_add_u32 v5, s32, v3
    s_mov_b32 s33, 3277
    s_cmp_eq_u32 s27, 1
    s_cselect_b32 s38, s26, 0
    s_cmp_ge_u32 s38, 5
    s_cbranch_scc1 qkv_kernel_epiK
    s_cmp_eq_u32 s27, 1
    s_cselect_b32 s38, 0x3ea52b5c, 1.0
    s_mov_b32 s39, 3840
    s_cselect_b32 s39, 1280, s39
    s_mov_b32 s40, 0
    s_cselect_b32 s40, 8388608, s40
    s_barrier
    v_add_u32 v6, s34, v3
    v_mul_u32_u24 v6, 272, v6
    v_lshrrev_b32 v7, 5, v2
    v_lshlrev_b32 v7, 3, v7
    s_lshl_b32 s41, s35, 1
    v_add3_u32 v6, v6, v7, s41
    v_mul_f32 v64, s38, v64
    v_mul_f32 v65, s38, v65
    v_mul_f32 v66, s38, v66
    v_mul_f32 v67, s38, v67
    v_cvt_pk_bf16_f32 v64, v64, v65
    v_cvt_pk_bf16_f32 v65, v66, v67
    ds_write_b64 v6, v[64:65] offset:0
    v_mul_f32 v68, s38, v68
    v_mul_f32 v69, s38, v69
    v_mul_f32 v70, s38, v70
    v_mul_f32 v71, s38, v71
    v_cvt_pk_bf16_f32 v68, v68, v69
    v_cvt_pk_bf16_f32 v69, v70, v71
    ds_write_b64 v6, v[68:69] offset:16
    v_mul_f32 v72, s38, v72
    v_mul_f32 v73, s38, v73
    v_mul_f32 v74, s38, v74
    v_mul_f32 v75, s38, v75
    v_cvt_pk_bf16_f32 v72, v72, v73
    v_cvt_pk_bf16_f32 v73, v74, v75
    ds_write_b64 v6, v[72:73] offset:32
    v_mul_f32 v76, s38, v76
    v_mul_f32 v77, s38, v77
    v_mul_f32 v78, s38, v78
    v_mul_f32 v79, s38, v79
    v_cvt_pk_bf16_f32 v76, v76, v77
    v_cvt_pk_bf16_f32 v77, v78, v79
    ds_write_b64 v6, v[76:77] offset:48
    v_mul_f32 v80, s38, v80
    v_mul_f32 v81, s38, v81
    v_mul_f32 v82, s38, v82
    v_mul_f32 v83, s38, v83
    v_cvt_pk_bf16_f32 v80, v80, v81
    v_cvt_pk_bf16_f32 v81, v82, v83
    ds_write_b64 v6, v[80:81] offset:64
    v_mul_f32 v84, s38, v84
    v_mul_f32 v85, s38, v85
    v_mul_f32 v86, s38, v86
    v_mul_f32 v87, s38, v87
    v_cvt_pk_bf16_f32 v84, v84, v85
    v_cvt_pk_bf16_f32 v85, v86, v87
    ds_write_b64 v6, v[84:85] offset:80
    v_mul_f32 v88, s38, v88
    v_mul_f32 v89, s38, v89
    v_mul_f32 v90, s38, v90
    v_mul_f32 v91, s38, v91
    v_cvt_pk_bf16_f32 v88, v88, v89
    v_cvt_pk_bf16_f32 v89, v90, v91
    ds_write_b64 v6, v[88:89] offset:96
    v_mul_f32 v92, s38, v92
    v_mul_f32 v93, s38, v93
    v_mul_f32 v94, s38, v94
    v_mul_f32 v95, s38, v95
    v_cvt_pk_bf16_f32 v92, v92, v93
    v_cvt_pk_bf16_f32 v93, v94, v95
    ds_write_b64 v6, v[92:93] offset:112
    v_mul_f32 v96, s38, v96
    v_mul_f32 v97, s38, v97
    v_mul_f32 v98, s38, v98
    v_mul_f32 v99, s38, v99
    v_cvt_pk_bf16_f32 v96, v96, v97
    v_cvt_pk_bf16_f32 v97, v98, v99
    ds_write_b64 v6, v[96:97] offset:8704
    v_mul_f32 v100, s38, v100
    v_mul_f32 v101, s38, v101
    v_mul_f32 v102, s38, v102
    v_mul_f32 v103, s38, v103
    v_cvt_pk_bf16_f32 v100, v100, v101
    v_cvt_pk_bf16_f32 v101, v102, v103
    ds_write_b64 v6, v[100:101] offset:8720
    v_mul_f32 v104, s38, v104
    v_mul_f32 v105, s38, v105
    v_mul_f32 v106, s38, v106
    v_mul_f32 v107, s38, v107
    v_cvt_pk_bf16_f32 v104, v104, v105
    v_cvt_pk_bf16_f32 v105, v106, v107
    ds_write_b64 v6, v[104:105] offset:8736
    v_mul_f32 v108, s38, v108
    v_mul_f32 v109, s38, v109
    v_mul_f32 v110, s38, v110
    v_mul_f32 v111, s38, v111
    v_cvt_pk_bf16_f32 v108, v108, v109
    v_cvt_pk_bf16_f32 v109, v110, v111
    ds_write_b64 v6, v[108:109] offset:8752
    v_mul_f32 v112, s38, v112
    v_mul_f32 v113, s38, v113
    v_mul_f32 v114, s38, v114
    v_mul_f32 v115, s38, v115
    v_cvt_pk_bf16_f32 v112, v112, v113
    v_cvt_pk_bf16_f32 v113, v114, v115
    ds_write_b64 v6, v[112:113] offset:8768
    v_mul_f32 v116, s38, v116
    v_mul_f32 v117, s38, v117
    v_mul_f32 v118, s38, v118
    v_mul_f32 v119, s38, v119
    v_cvt_pk_bf16_f32 v116, v116, v117
    v_cvt_pk_bf16_f32 v117, v118, v119
    ds_write_b64 v6, v[116:117] offset:8784
    v_mul_f32 v120, s38, v120
    v_mul_f32 v121, s38, v121
    v_mul_f32 v122, s38, v122
    v_mul_f32 v123, s38, v123
    v_cvt_pk_bf16_f32 v120, v120, v121
    v_cvt_pk_bf16_f32 v121, v122, v123
    ds_write_b64 v6, v[120:121] offset:8800
    v_mul_f32 v124, s38, v124
    v_mul_f32 v125, s38, v125
    v_mul_f32 v126, s38, v126
    v_mul_f32 v127, s38, v127
    v_cvt_pk_bf16_f32 v124, v124, v125
    v_cvt_pk_bf16_f32 v125, v126, v127
    ds_write_b64 v6, v[124:125] offset:8816
    s_waitcnt lgkmcnt(0)
    s_barrier
    s_cmp_eq_u32 s27, 1
    s_cbranch_scc1 qkv_kernel_epiQ2
    v_lshrrev_b32 v6, 4, v2
    s_lshl_b32 s41, s24, 5
    v_add_u32 v6, s41, v6
    v_and_b32 v7, 15, v2
    v_lshlrev_b32 v7, 4, v7
    v_mul_u32_u24 v8, 272, v6
    v_add_u32 v8, v8, v7
    s_lshl_b32 s41, s25, 8
    v_add_u32 v6, s41, v6
    v_mul_lo_u32 v6, v6, s39
    s_lshl_b32 s41, s26, 8
    s_add_u32 s41, s41, s40
    v_add3_u32 v6, v6, v7, s41
    s_lshl_b32 s41, s39, 2
    ds_read_b128 v[64:67], v8 offset:0
    ds_read_b128 v[68:71], v8 offset:1088
    ds_read_b128 v[72:75], v8 offset:2176
    ds_read_b128 v[76:79], v8 offset:3264
    ds_read_b128 v[80:83], v8 offset:4352
    ds_read_b128 v[84:87], v8 offset:5440
    ds_read_b128 v[88:91], v8 offset:6528
    ds_read_b128 v[92:95], v8 offset:7616
    s_waitcnt lgkmcnt(7)
    buffer_store_dwordx4 v[64:67], v6, s[20:23], 0 offen
    v_add_u32 v6, s41, v6
    s_waitcnt lgkmcnt(6)
    buffer_store_dwordx4 v[68:71], v6, s[20:23], 0 offen
    v_add_u32 v6, s41, v6
    s_waitcnt lgkmcnt(5)
    buffer_store_dwordx4 v[72:75], v6, s[20:23], 0 offen
    v_add_u32 v6, s41, v6
    s_waitcnt lgkmcnt(4)
    buffer_store_dwordx4 v[76:79], v6, s[20:23], 0 offen
    v_add_u32 v6, s41, v6
    s_waitcnt lgkmcnt(3)
    buffer_store_dwordx4 v[80:83], v6, s[20:23], 0 offen
    v_add_u32 v6, s41, v6
    s_waitcnt lgkmcnt(2)
    buffer_store_dwordx4 v[84:87], v6, s[20:23], 0 offen
    v_add_u32 v6, s41, v6
    s_waitcnt lgkmcnt(1)
    buffer_store_dwordx4 v[88:91], v6, s[20:23], 0 offen
    v_add_u32 v6, s41, v6
    s_waitcnt lgkmcnt(0)
    buffer_store_dwordx4 v[92:95], v6, s[20:23], 0 offen
    s_branch qkv_kernel_done
qkv_kernel_epiQ2:
    v_and_b32 v7, 31, v2
    v_lshlrev_b32 v1, 2, v7
    s_lshl_b32 s41, s26, 7
    v_add_u32 v1, s41, v1
    v_mul_u32_u24 v8, s33, v1
    v_lshrrev_b32 v8, 16, v8
    v_mul_u32_u24 v9, 20, v8
    v_sub_u32 v9, v1, v9
    s_mov_b32 s41, 81920
    v_mul_lo_u32 v8, v8, s41
    v_lshl_add_u32 v8, v9, 1, v8
    v_lshrrev_b32 v6, 5, v2
    s_lshl_b32 s41, s24, 5
    v_add_u32 v6, s41, v6
    v_mul_u32_u24 v9, 272, v6
    v_lshl_add_u32 v9, v7, 3, v9
    s_lshl_b32 s41, s25, 8
    v_add_u32 v6, s41, v6
    v_mad_u32_u24 v8, v6, 40, v8
    v_add_u32 v8, 8388608, v8
    ds_read_b64 v[64:65], v9 offset:0
    ds_read_b64 v[66:67], v9 offset:544
    ds_read_b64 v[68:69], v9 offset:1088
    ds_read_b64 v[70:71], v9 offset:1632
    ds_read_b64 v[72:73], v9 offset:2176
    ds_read_b64 v[74:75], v9 offset:2720
    ds_read_b64 v[76:77], v9 offset:3264
    ds_read_b64 v[78:79], v9 offset:3808
    ds_read_b64 v[80:81], v9 offset:4352
    ds_read_b64 v[82:83], v9 offset:4896
    ds_read_b64 v[84:85], v9 offset:5440
    ds_read_b64 v[86:87], v9 offset:5984
    ds_read_b64 v[88:89], v9 offset:6528
    ds_read_b64 v[90:91], v9 offset:7072
    ds_read_b64 v[92:93], v9 offset:7616
    ds_read_b64 v[94:95], v9 offset:8160
    s_waitcnt lgkmcnt(15)
    buffer_store_dwordx2 v[64:65], v8, s[20:23], 0 offen offset:0
    s_waitcnt lgkmcnt(14)
    buffer_store_dwordx2 v[66:67], v8, s[20:23], 0 offen offset:80
    s_waitcnt lgkmcnt(13)
    buffer_store_dwordx2 v[68:69], v8, s[20:23], 0 offen offset:160
    s_waitcnt lgkmcnt(12)
    buffer_store_dwordx2 v[70:71], v8, s[20:23], 0 offen offset:240
    s_waitcnt lgkmcnt(11)
    buffer_store_dwordx2 v[72:73], v8, s[20:23], 0 offen offset:320
    s_waitcnt lgkmcnt(10)
    buffer_store_dwordx2 v[74:75], v8, s[20:23], 0 offen offset:400
    s_waitcnt lgkmcnt(9)
    buffer_store_dwordx2 v[76:77], v8, s[20:23], 0 offen offset:480
    s_waitcnt lgkmcnt(8)
    buffer_store_dwordx2 v[78:79], v8, s[20:23], 0 offen offset:560
    s_waitcnt lgkmcnt(7)
    buffer_store_dwordx2 v[80:81], v8, s[20:23], 0 offen offset:640
    s_waitcnt lgkmcnt(6)
    buffer_store_dwordx2 v[82:83], v8, s[20:23], 0 offen offset:720
    s_waitcnt lgkmcnt(5)
    buffer_store_dwordx2 v[84:85], v8, s[20:23], 0 offen offset:800
    s_waitcnt lgkmcnt(4)
    buffer_store_dwordx2 v[86:87], v8, s[20:23], 0 offen offset:880
    s_waitcnt lgkmcnt(3)
    buffer_store_dwordx2 v[88:89], v8, s[20:23], 0 offen offset:960
    s_waitcnt lgkmcnt(2)
    buffer_store_dwordx2 v[90:91], v8, s[20:23], 0 offen offset:1040
    s_waitcnt lgkmcnt(1)
    buffer_store_dwordx2 v[92:93], v8, s[20:23], 0 offen offset:1120
    s_waitcnt lgkmcnt(0)
    buffer_store_dwordx2 v[94:95], v8, s[20:23], 0 offen offset:1200
    s_branch qkv_kernel_done
qkv_kernel_epiK:
    v_subrev_u32 v4, 640, v4
    s_lshr_b32 s32, s32, 5
    s_mul_i32 s32, s32, 3072
    s_add_u32 s32, s32, 12582912
    v_lshlrev_b32 v5, 4, v3
    v_add_u32 v5, s32, v5
    s_mov_b32 s31, 196608
    v_mov_b32 v32, 0
    v_mov_b32 v33, 0
    v_add_u32 v1, 0, v4
    v_mul_u32_u24 v6, s33, v1
    v_lshrrev_b32 v6, 16, v6
    v_mul_u32_u24 v7, 20, v6
    v_sub_u32 v7, v1, v7
    v_mul_u32_u24 v6, s31, v6
    v_lshrrev_b32 v1, 3, v7
    v_lshl_add_u32 v6, v1, 9, v6
    v_and_b32 v1, 7, v7
    v_lshl_add_u32 v6, v1, 1, v6
    v_add_u32 v6, v6, v5
    v_cmp_eq_u32 vcc, 16, v7
    v_cvt_pk_bf16_f32 v64, v64, v65
    v_cvt_pk_bf16_f32 v65, v66, v67
    buffer_store_dwordx2 v[64:65], v6, s[20:23], 0 offen offset:0
    v_cvt_pk_bf16_f32 v96, v96, v97
    v_cvt_pk_bf16_f32 v97, v98, v99
    buffer_store_dwordx2 v[96:97], v6, s[20:23], 0 offen offset:3072
    s_and_saveexec_b64 s[38:39], vcc
    s_cbranch_execz qkv_kernel_kz_0_0
    buffer_store_dwordx2 v[32:33], v6, s[20:23], 0 offen offset:8
    buffer_store_dwordx2 v[32:33], v6, s[20:23], 0 offen offset:3080
qkv_kernel_kz_0_0:
    s_mov_b64 exec, s[38:39]
    v_add_u32 v1, 8, v4
    v_mul_u32_u24 v6, s33, v1
    v_lshrrev_b32 v6, 16, v6
    v_mul_u32_u24 v7, 20, v6
    v_sub_u32 v7, v1, v7
    v_mul_u32_u24 v6, s31, v6
    v_lshrrev_b32 v1, 3, v7
    v_lshl_add_u32 v6, v1, 9, v6
    v_and_b32 v1, 7, v7
    v_lshl_add_u32 v6, v1, 1, v6
    v_add_u32 v6, v6, v5
    v_cmp_eq_u32 vcc, 16, v7
    v_cvt_pk_bf16_f32 v68, v68, v69
    v_cvt_pk_bf16_f32 v69, v70, v71
    buffer_store_dwordx2 v[68:69], v6, s[20:23], 0 offen offset:0
    v_cvt_pk_bf16_f32 v100, v100, v101
    v_cvt_pk_bf16_f32 v101, v102, v103
    buffer_store_dwordx2 v[100:101], v6, s[20:23], 0 offen offset:3072
    s_and_saveexec_b64 s[38:39], vcc
    s_cbranch_execz qkv_kernel_kz_0_1
    buffer_store_dwordx2 v[32:33], v6, s[20:23], 0 offen offset:8
    buffer_store_dwordx2 v[32:33], v6, s[20:23], 0 offen offset:3080
qkv_kernel_kz_0_1:
    s_mov_b64 exec, s[38:39]
    v_add_u32 v1, 16, v4
    v_mul_u32_u24 v6, s33, v1
    v_lshrrev_b32 v6, 16, v6
    v_mul_u32_u24 v7, 20, v6
    v_sub_u32 v7, v1, v7
    v_mul_u32_u24 v6, s31, v6
    v_lshrrev_b32 v1, 3, v7
    v_lshl_add_u32 v6, v1, 9, v6
    v_and_b32 v1, 7, v7
    v_lshl_add_u32 v6, v1, 1, v6
    v_add_u32 v6, v6, v5
    v_cmp_eq_u32 vcc, 16, v7
    v_cvt_pk_bf16_f32 v72, v72, v73
    v_cvt_pk_bf16_f32 v73, v74, v75
    buffer_store_dwordx2 v[72:73], v6, s[20:23], 0 offen offset:0
    v_cvt_pk_bf16_f32 v104, v104, v105
    v_cvt_pk_bf16_f32 v105, v106, v107
    buffer_store_dwordx2 v[104:105], v6, s[20:23], 0 offen offset:3072
    s_and_saveexec_b64 s[38:39], vcc
    s_cbranch_execz qkv_kernel_kz_0_2
    buffer_store_dwordx2 v[32:33], v6, s[20:23], 0 offen offset:8
    buffer_store_dwordx2 v[32:33], v6, s[20:23], 0 offen offset:3080
qkv_kernel_kz_0_2:
    s_mov_b64 exec, s[38:39]
    v_add_u32 v1, 24, v4
    v_mul_u32_u24 v6, s33, v1
    v_lshrrev_b32 v6, 16, v6
    v_mul_u32_u24 v7, 20, v6
    v_sub_u32 v7, v1, v7
    v_mul_u32_u24 v6, s31, v6
    v_lshrrev_b32 v1, 3, v7
    v_lshl_add_u32 v6, v1, 9, v6
    v_and_b32 v1, 7, v7
    v_lshl_add_u32 v6, v1, 1, v6
    v_add_u32 v6, v6, v5
    v_cmp_eq_u32 vcc, 16, v7
    v_cvt_pk_bf16_f32 v76, v76, v77
    v_cvt_pk_bf16_f32 v77, v78, v79
    buffer_store_dwordx2 v[76:77], v6, s[20:23], 0 offen offset:0
    v_cvt_pk_bf16_f32 v108, v108, v109
    v_cvt_pk_bf16_f32 v109, v110, v111
    buffer_store_dwordx2 v[108:109], v6, s[20:23], 0 offen offset:3072
    s_and_saveexec_b64 s[38:39], vcc
    s_cbranch_execz qkv_kernel_kz_0_3
    buffer_store_dwordx2 v[32:33], v6, s[20:23], 0 offen offset:8
    buffer_store_dwordx2 v[32:33], v6, s[20:23], 0 offen offset:3080
qkv_kernel_kz_0_3:
    s_mov_b64 exec, s[38:39]
    v_add_u32 v1, 32, v4
    v_mul_u32_u24 v6, s33, v1
    v_lshrrev_b32 v6, 16, v6
    v_mul_u32_u24 v7, 20, v6
    v_sub_u32 v7, v1, v7
    v_mul_u32_u24 v6, s31, v6
    v_lshrrev_b32 v1, 3, v7
    v_lshl_add_u32 v6, v1, 9, v6
    v_and_b32 v1, 7, v7
    v_lshl_add_u32 v6, v1, 1, v6
    v_add_u32 v6, v6, v5
    v_cmp_eq_u32 vcc, 16, v7
    v_cvt_pk_bf16_f32 v80, v80, v81
    v_cvt_pk_bf16_f32 v81, v82, v83
    buffer_store_dwordx2 v[80:81], v6, s[20:23], 0 offen offset:0
    v_cvt_pk_bf16_f32 v112, v112, v113
    v_cvt_pk_bf16_f32 v113, v114, v115
    buffer_store_dwordx2 v[112:113], v6, s[20:23], 0 offen offset:3072
    s_and_saveexec_b64 s[38:39], vcc
    s_cbranch_execz qkv_kernel_kz_1_0
    buffer_store_dwordx2 v[32:33], v6, s[20:23], 0 offen offset:8
    buffer_store_dwordx2 v[32:33], v6, s[20:23], 0 offen offset:3080
qkv_kernel_kz_1_0:
    s_mov_b64 exec, s[38:39]
    v_add_u32 v1, 40, v4
    v_mul_u32_u24 v6, s33, v1
    v_lshrrev_b32 v6, 16, v6
    v_mul_u32_u24 v7, 20, v6
    v_sub_u32 v7, v1, v7
    v_mul_u32_u24 v6, s31, v6
    v_lshrrev_b32 v1, 3, v7
    v_lshl_add_u32 v6, v1, 9, v6
    v_and_b32 v1, 7, v7
    v_lshl_add_u32 v6, v1, 1, v6
    v_add_u32 v6, v6, v5
    v_cmp_eq_u32 vcc, 16, v7
    v_cvt_pk_bf16_f32 v84, v84, v85
    v_cvt_pk_bf16_f32 v85, v86, v87
    buffer_store_dwordx2 v[84:85], v6, s[20:23], 0 offen offset:0
    v_cvt_pk_bf16_f32 v116, v116, v117
    v_cvt_pk_bf16_f32 v117, v118, v119
    buffer_store_dwordx2 v[116:117], v6, s[20:23], 0 offen offset:3072
    s_and_saveexec_b64 s[38:39], vcc
    s_cbranch_execz qkv_kernel_kz_1_1
    buffer_store_dwordx2 v[32:33], v6, s[20:23], 0 offen offset:8
    buffer_store_dwordx2 v[32:33], v6, s[20:23], 0 offen offset:3080
qkv_kernel_kz_1_1:
    s_mov_b64 exec, s[38:39]
    v_add_u32 v1, 48, v4
    v_mul_u32_u24 v6, s33, v1
    v_lshrrev_b32 v6, 16, v6
    v_mul_u32_u24 v7, 20, v6
    v_sub_u32 v7, v1, v7
    v_mul_u32_u24 v6, s31, v6
    v_lshrrev_b32 v1, 3, v7
    v_lshl_add_u32 v6, v1, 9, v6
    v_and_b32 v1, 7, v7
    v_lshl_add_u32 v6, v1, 1, v6
    v_add_u32 v6, v6, v5
    v_cmp_eq_u32 vcc, 16, v7
    v_cvt_pk_bf16_f32 v88, v88, v89
    v_cvt_pk_bf16_f32 v89, v90, v91
    buffer_store_dwordx2 v[88:89], v6, s[20:23], 0 offen offset:0
    v_cvt_pk_bf16_f32 v120, v120, v121
    v_cvt_pk_bf16_f32 v121, v122, v123
    buffer_store_dwordx2 v[120:121], v6, s[20:23], 0 offen offset:3072
    s_and_saveexec_b64 s[38:39], vcc
    s_cbranch_execz qkv_kernel_kz_1_2
    buffer_store_dwordx2 v[32:33], v6, s[20:23], 0 offen offset:8
    buffer_store_dwordx2 v[32:33], v6, s[20:23], 0 offen offset:3080
qkv_kernel_kz_1_2:
    s_mov_b64 exec, s[38:39]
    v_add_u32 v1, 56, v4
    v_mul_u32_u24 v6, s33, v1
    v_lshrrev_b32 v6, 16, v6
    v_mul_u32_u24 v7, 20, v6
    v_sub_u32 v7, v1, v7
    v_mul_u32_u24 v6, s31, v6
    v_lshrrev_b32 v1, 3, v7
    v_lshl_add_u32 v6, v1, 9, v6
    v_and_b32 v1, 7, v7
    v_lshl_add_u32 v6, v1, 1, v6
    v_add_u32 v6, v6, v5
    v_cmp_eq_u32 vcc, 16, v7
    v_cvt_pk_bf16_f32 v92, v92, v93
    v_cvt_pk_bf16_f32 v93, v94, v95
    buffer_store_dwordx2 v[92:93], v6, s[20:23], 0 offen offset:0
    v_cvt_pk_bf16_f32 v124, v124, v125
    v_cvt_pk_bf16_f32 v125, v126, v127
    buffer_store_dwordx2 v[124:125], v6, s[20:23], 0 offen offset:3072
    s_and_saveexec_b64 s[38:39], vcc
    s_cbranch_execz qkv_kernel_kz_1_3
    buffer_store_dwordx2 v[32:33], v6, s[20:23], 0 offen offset:8
    buffer_store_dwordx2 v[32:33], v6, s[20:23], 0 offen offset:3080
qkv_kernel_kz_1_3:
    s_mov_b64 exec, s[38:39]
    s_branch qkv_kernel_done
qkv_kernel_vtile:
    v_mov_b32 v64, 0
    v_mov_b32 v65, 0
    v_mov_b32 v66, 0
    v_mov_b32 v67, 0
    v_mov_b32 v68, 0
    v_mov_b32 v69, 0
    v_mov_b32 v70, 0
    v_mov_b32 v71, 0
    v_mov_b32 v72, 0
    v_mov_b32 v73, 0
    v_mov_b32 v74, 0
    v_mov_b32 v75, 0
    v_mov_b32 v76, 0
    v_mov_b32 v77, 0
    v_mov_b32 v78, 0
    v_mov_b32 v79, 0
    v_mov_b32 v80, 0
    v_mov_b32 v81, 0
    v_mov_b32 v82, 0
    v_mov_b32 v83, 0
    v_mov_b32 v84, 0
    v_mov_b32 v85, 0
    v_mov_b32 v86, 0
    v_mov_b32 v87, 0
    v_mov_b32 v88, 0
    v_mov_b32 v89, 0
    v_mov_b32 v90, 0
    v_mov_b32 v91, 0
    v_mov_b32 v92, 0
    v_mov_b32 v93, 0
    v_mov_b32 v94, 0
    v_mov_b32 v95, 0
    v_mov_b32 v96, 0
    v_mov_b32 v97, 0
    v_mov_b32 v98, 0
    v_mov_b32 v99, 0
    v_mov_b32 v100, 0
    v_mov_b32 v101, 0
    v_mov_b32 v102, 0
    v_mov_b32 v103, 0
    v_mov_b32 v104, 0
    v_mov_b32 v105, 0
    v_mov_b32 v106, 0
    v_mov_b32 v107, 0
    v_mov_b32 v108, 0
    v_mov_b32 v109, 0
    v_mov_b32 v110, 0
    v_mov_b32 v111, 0
    v_mov_b32 v112, 0
    v_mov_b32 v113, 0
    v_mov_b32 v114, 0
    v_mov_b32 v115, 0
    v_mov_b32 v116, 0
    v_mov_b32 v117, 0
    v_mov_b32 v118, 0
    v_mov_b32 v119, 0
    v_mov_b32 v120, 0
    v_mov_b32 v121, 0
    v_mov_b32 v122, 0
    v_mov_b32 v123, 0
    v_mov_b32 v124, 0
    v_mov_b32 v125, 0
    v_mov_b32 v126, 0
    v_mov_b32 v127, 0
    s_lshl_b32 s30, s42, 7
    s_add_u32 m0, s28, 0
    s_nop 0
    buffer_load_dwordx4 v8, s[12:15], s30 offen lds
    s_add_u32 m0, s28, 1024
    s_nop 0
    buffer_load_dwordx4 v9, s[12:15], s30 offen lds
    s_add_u32 m0, s28, 2048
    s_nop 0
    buffer_load_dwordx4 v10, s[12:15], s30 offen lds
    s_add_u32 m0, s28, 3072
    s_nop 0
    buffer_load_dwordx4 v11, s[12:15], s30 offen lds
    s_mul_i32 s30, s42, 245760
    s_add_u32 m0, s29, 0
    s_nop 0
    buffer_load_dwordx4 v12, s[16:19], s30 offen lds
    s_add_u32 m0, s29, 1024
    s_nop 0
    buffer_load_dwordx4 v13, s[16:19], s30 offen lds
    s_add_u32 s42, s42, 1
    s_cmp_eq_u32 s42, 10
    s_cselect_b32 s42, 0, s42
    s_lshl_b32 s30, s42, 7
    s_add_u32 m0, s28, 49152
    s_nop 0
    buffer_load_dwordx4 v8, s[12:15], s30 offen lds
    s_add_u32 m0, s28, 50176
    s_nop 0
    buffer_load_dwordx4 v9, s[12:15], s30 offen lds
    s_add_u32 m0, s28, 51200
    s_nop 0
    buffer_load_dwordx4 v10, s[12:15], s30 offen lds
    s_add_u32 m0, s28, 52224
    s_nop 0
    buffer_load_dwordx4 v11, s[12:15], s30 offen lds
    s_mul_i32 s30, s42, 245760
    s_add_u32 m0, s29, 49152
    s_nop 0
    buffer_load_dwordx4 v12, s[16:19], s30 offen lds
    s_add_u32 m0, s29, 50176
    s_nop 0
    buffer_load_dwordx4 v13, s[16:19], s30 offen lds
    s_add_u32 s42, s42, 1
    s_cmp_eq_u32 s42, 10
    s_cselect_b32 s42, 0, s42
    s_waitcnt vmcnt(6)
    s_barrier
    ds_read_b128 v[32:35], v14 offset:0
    ds_read_b128 v[36:39], v14 offset:4096
    ds_read_b64_tr_b16 v[48:49], v26 offset:0
    ds_read_b64_tr_b16 v[50:51], v26 offset:1024
    ds_read_b64_tr_b16 v[52:53], v27 offset:0
    ds_read_b64_tr_b16 v[54:55], v27 offset:1024
    s_lshl_b32 s30, s42, 7
    s_add_u32 m0, s28, 98304
    s_nop 0
    buffer_load_dwordx4 v8, s[12:15], s30 offen lds
    s_add_u32 m0, s28, 99328
    s_nop 0
    buffer_load_dwordx4 v9, s[12:15], s30 offen lds
    s_add_u32 m0, s28, 100352
    s_nop 0
    buffer_load_dwordx4 v10, s[12:15], s30 offen lds
    s_add_u32 m0, s28, 101376
    s_nop 0
    buffer_load_dwordx4 v11, s[12:15], s30 offen lds
    s_mul_i32 s30, s42, 245760
    s_add_u32 m0, s29, 98304
    s_nop 0
    buffer_load_dwordx4 v12, s[16:19], s30 offen lds
    s_add_u32 m0, s29, 99328
    s_nop 0
    buffer_load_dwordx4 v13, s[16:19], s30 offen lds
    s_add_u32 s42, s42, 1
    s_cmp_eq_u32 s42, 10
    s_cselect_b32 s42, 0, s42
    ds_read_b128 v[40:43], v15 offset:0
    ds_read_b128 v[44:47], v15 offset:4096
    ds_read_b64_tr_b16 v[56:57], v26 offset:4096
    ds_read_b64_tr_b16 v[58:59], v26 offset:5120
    ds_read_b64_tr_b16 v[60:61], v27 offset:4096
    ds_read_b64_tr_b16 v[62:63], v27 offset:5120
    s_waitcnt lgkmcnt(6)
    v_mfma_f32_32x32x16_bf16 v[64:79], v[32:35], v[48:51], v[64:79]
    v_mfma_f32_32x32x16_bf16 v[80:95], v[32:35], v[52:55], v[80:95]
    v_mfma_f32_32x32x16_bf16 v[96:111], v[36:39], v[48:51], v[96:111]
    v_mfma_f32_32x32x16_bf16 v[112:127], v[36:39], v[52:55], v[112:127]
    ds_read_b128 v[32:35], v16 offset:0
    ds_read_b128 v[36:39], v16 offset:4096
    ds_read_b64_tr_b16 v[48:49], v26 offset:8192
    ds_read_b64_tr_b16 v[50:51], v26 offset:9216
    ds_read_b64_tr_b16 v[52:53], v27 offset:8192
    ds_read_b64_tr_b16 v[54:55], v27 offset:9216
    s_waitcnt lgkmcnt(6)
    v_mfma_f32_32x32x16_bf16 v[64:79], v[40:43], v[56:59], v[64:79]
    v_mfma_f32_32x32x16_bf16 v[80:95], v[40:43], v[60:63], v[80:95]
    v_mfma_f32_32x32x16_bf16 v[96:111], v[44:47], v[56:59], v[96:111]
    v_mfma_f32_32x32x16_bf16 v[112:127], v[44:47], v[60:63], v[112:127]
    ds_read_b128 v[40:43], v17 offset:0
    ds_read_b128 v[44:47], v17 offset:4096
    ds_read_b64_tr_b16 v[56:57], v26 offset:12288
    ds_read_b64_tr_b16 v[58:59], v26 offset:13312
    ds_read_b64_tr_b16 v[60:61], v27 offset:12288
    ds_read_b64_tr_b16 v[62:63], v27 offset:13312
    s_waitcnt lgkmcnt(6)
    v_mfma_f32_32x32x16_bf16 v[64:79], v[32:35], v[48:51], v[64:79]
    v_mfma_f32_32x32x16_bf16 v[80:95], v[32:35], v[52:55], v[80:95]
    v_mfma_f32_32x32x16_bf16 v[96:111], v[36:39], v[48:51], v[96:111]
    v_mfma_f32_32x32x16_bf16 v[112:127], v[36:39], v[52:55], v[112:127]
    s_waitcnt lgkmcnt(0)
    v_mfma_f32_32x32x16_bf16 v[64:79], v[40:43], v[56:59], v[64:79]
    v_mfma_f32_32x32x16_bf16 v[80:95], v[40:43], v[60:63], v[80:95]
    v_mfma_f32_32x32x16_bf16 v[96:111], v[44:47], v[56:59], v[96:111]
    v_mfma_f32_32x32x16_bf16 v[112:127], v[44:47], v[60:63], v[112:127]
    s_waitcnt vmcnt(6)
    s_barrier
    ds_read_b128 v[32:35], v18 offset:0
    ds_read_b128 v[36:39], v18 offset:4096
    ds_read_b64_tr_b16 v[48:49], v28 offset:0
    ds_read_b64_tr_b16 v[50:51], v28 offset:1024
    ds_read_b64_tr_b16 v[52:53], v29 offset:0
    ds_read_b64_tr_b16 v[54:55], v29 offset:1024
    s_lshl_b32 s30, s42, 7
    s_add_u32 m0, s28, 0
    s_nop 0
    buffer_load_dwordx4 v8, s[12:15], s30 offen lds
    s_add_u32 m0, s28, 1024
    s_nop 0
    buffer_load_dwordx4 v9, s[12:15], s30 offen lds
    s_add_u32 m0, s28, 2048
    s_nop 0
    buffer_load_dwordx4 v10, s[12:15], s30 offen lds
    s_add_u32 m0, s28, 3072
    s_nop 0
    buffer_load_dwordx4 v11, s[12:15], s30 offen lds
    s_mul_i32 s30, s42, 245760
    s_add_u32 m0, s29, 0
    s_nop 0
    buffer_load_dwordx4 v12, s[16:19], s30 offen lds
    s_add_u32 m0, s29, 1024
    s_nop 0
    buffer_load_dwordx4 v13, s[16:19], s30 offen lds
    s_add_u32 s42, s42, 1
    s_cmp_eq_u32 s42, 10
    s_cselect_b32 s42, 0, s42
    ds_read_b128 v[40:43], v19 offset:0
    ds_read_b128 v[44:47], v19 offset:4096
    ds_read_b64_tr_b16 v[56:57], v28 offset:4096
    ds_read_b64_tr_b16 v[58:59], v28 offset:5120
    ds_read_b64_tr_b16 v[60:61], v29 offset:4096
    ds_read_b64_tr_b16 v[62:63], v29 offset:5120
    s_waitcnt lgkmcnt(6)
    v_mfma_f32_32x32x16_bf16 v[64:79], v[32:35], v[48:51], v[64:79]
    v_mfma_f32_32x32x16_bf16 v[80:95], v[32:35], v[52:55], v[80:95]
    v_mfma_f32_32x32x16_bf16 v[96:111], v[36:39], v[48:51], v[96:111]
    v_mfma_f32_32x32x16_bf16 v[112:127], v[36:39], v[52:55], v[112:127]
    ds_read_b128 v[32:35], v20 offset:0
    ds_read_b128 v[36:39], v20 offset:4096
    ds_read_b64_tr_b16 v[48:49], v28 offset:8192
    ds_read_b64_tr_b16 v[50:51], v28 offset:9216
    ds_read_b64_tr_b16 v[52:53], v29 offset:8192
    ds_read_b64_tr_b16 v[54:55], v29 offset:9216
    s_waitcnt lgkmcnt(6)
    v_mfma_f32_32x32x16_bf16 v[64:79], v[40:43], v[56:59], v[64:79]
    v_mfma_f32_32x32x16_bf16 v[80:95], v[40:43], v[60:63], v[80:95]
    v_mfma_f32_32x32x16_bf16 v[96:111], v[44:47], v[56:59], v[96:111]
    v_mfma_f32_32x32x16_bf16 v[112:127], v[44:47], v[60:63], v[112:127]
    ds_read_b128 v[40:43], v21 offset:0
    ds_read_b128 v[44:47], v21 offset:4096
    ds_read_b64_tr_b16 v[56:57], v28 offset:12288
    ds_read_b64_tr_b16 v[58:59], v28 offset:13312
    ds_read_b64_tr_b16 v[60:61], v29 offset:12288
    ds_read_b64_tr_b16 v[62:63], v29 offset:13312
    s_waitcnt lgkmcnt(6)
    v_mfma_f32_32x32x16_bf16 v[64:79], v[32:35], v[48:51], v[64:79]
    v_mfma_f32_32x32x16_bf16 v[80:95], v[32:35], v[52:55], v[80:95]
    v_mfma_f32_32x32x16_bf16 v[96:111], v[36:39], v[48:51], v[96:111]
    v_mfma_f32_32x32x16_bf16 v[112:127], v[36:39], v[52:55], v[112:127]
    s_waitcnt lgkmcnt(0)
    v_mfma_f32_32x32x16_bf16 v[64:79], v[40:43], v[56:59], v[64:79]
    v_mfma_f32_32x32x16_bf16 v[80:95], v[40:43], v[60:63], v[80:95]
    v_mfma_f32_32x32x16_bf16 v[96:111], v[44:47], v[56:59], v[96:111]
    v_mfma_f32_32x32x16_bf16 v[112:127], v[44:47], v[60:63], v[112:127]
    s_waitcnt vmcnt(6)
    s_barrier
    ds_read_b128 v[32:35], v22 offset:0
    ds_read_b128 v[36:39], v22 offset:4096
    ds_read_b64_tr_b16 v[48:49], v30 offset:0
    ds_read_b64_tr_b16 v[50:51], v30 offset:1024
    ds_read_b64_tr_b16 v[52:53], v31 offset:0
    ds_read_b64_tr_b16 v[54:55], v31 offset:1024
    s_lshl_b32 s30, s42, 7
    s_add_u32 m0, s28, 49152
    s_nop 0
    buffer_load_dwordx4 v8, s[12:15], s30 offen lds
    s_add_u32 m0, s28, 50176
    s_nop 0
    buffer_load_dwordx4 v9, s[12:15], s30 offen lds
    s_add_u32 m0, s28, 51200
    s_nop 0
    buffer_load_dwordx4 v10, s[12:15], s30 offen lds
    s_add_u32 m0, s28, 52224
    s_nop 0
    buffer_load_dwordx4 v11, s[12:15], s30 offen lds
    s_mul_i32 s30, s42, 245760
    s_add_u32 m0, s29, 49152
    s_nop 0
    buffer_load_dwordx4 v12, s[16:19], s30 offen lds
    s_add_u32 m0, s29, 50176
    s_nop 0
    buffer_load_dwordx4 v13, s[16:19], s30 offen lds
    s_add_u32 s42, s42, 1
    s_cmp_eq_u32 s42, 10
    s_cselect_b32 s42, 0, s42
    ds_read_b128 v[40:43], v23 offset:0
    ds_read_b128 v[44:47], v23 offset:4096
    ds_read_b64_tr_b16 v[56:57], v30 offset:4096
    ds_read_b64_tr_b16 v[58:59], v30 offset:5120
    ds_read_b64_tr_b16 v[60:61], v31 offset:4096
    ds_read_b64_tr_b16 v[62:63], v31 offset:5120
    s_waitcnt lgkmcnt(6)
    v_mfma_f32_32x32x16_bf16 v[64:79], v[32:35], v[48:51], v[64:79]
    v_mfma_f32_32x32x16_bf16 v[80:95], v[32:35], v[52:55], v[80:95]
    v_mfma_f32_32x32x16_bf16 v[96:111], v[36:39], v[48:51], v[96:111]
    v_mfma_f32_32x32x16_bf16 v[112:127], v[36:39], v[52:55], v[112:127]
    ds_read_b128 v[32:35], v24 offset:0
    ds_read_b128 v[36:39], v24 offset:4096
    ds_read_b64_tr_b16 v[48:49], v30 offset:8192
    ds_read_b64_tr_b16 v[50:51], v30 offset:9216
    ds_read_b64_tr_b16 v[52:53], v31 offset:8192
    ds_read_b64_tr_b16 v[54:55], v31 offset:9216
    s_waitcnt lgkmcnt(6)
    v_mfma_f32_32x32x16_bf16 v[64:79], v[40:43], v[56:59], v[64:79]
    v_mfma_f32_32x32x16_bf16 v[80:95], v[40:43], v[60:63], v[80:95]
    v_mfma_f32_32x32x16_bf16 v[96:111], v[44:47], v[56:59], v[96:111]
    v_mfma_f32_32x32x16_bf16 v[112:127], v[44:47], v[60:63], v[112:127]
    ds_read_b128 v[40:43], v25 offset:0
    ds_read_b128 v[44:47], v25 offset:4096
    ds_read_b64_tr_b16 v[56:57], v30 offset:12288
    ds_read_b64_tr_b16 v[58:59], v30 offset:13312
    ds_read_b64_tr_b16 v[60:61], v31 offset:12288
    ds_read_b64_tr_b16 v[62:63], v31 offset:13312
    s_waitcnt lgkmcnt(6)
    v_mfma_f32_32x32x16_bf16 v[64:79], v[32:35], v[48:51], v[64:79]
    v_mfma_f32_32x32x16_bf16 v[80:95], v[32:35], v[52:55], v[80:95]
    v_mfma_f32_32x32x16_bf16 v[96:111], v[36:39], v[48:51], v[96:111]
    v_mfma_f32_32x32x16_bf16 v[112:127], v[36:39], v[52:55], v[112:127]
    s_waitcnt lgkmcnt(0)
    v_mfma_f32_32x32x16_bf16 v[64:79], v[40:43], v[56:59], v[64:79]
    v_mfma_f32_32x32x16_bf16 v[80:95], v[40:43], v[60:63], v[80:95]
    v_mfma_f32_32x32x16_bf16 v[96:111], v[44:47], v[56:59], v[96:111]
    v_mfma_f32_32x32x16_bf16 v[112:127], v[44:47], v[60:63], v[112:127]
    s_waitcnt vmcnt(6)
    s_barrier
    ds_read_b128 v[32:35], v14 offset:0
    ds_read_b128 v[36:39], v14 offset:4096
    ds_read_b64_tr_b16 v[48:49], v26 offset:0
    ds_read_b64_tr_b16 v[50:51], v26 offset:1024
    ds_read_b64_tr_b16 v[52:53], v27 offset:0
    ds_read_b64_tr_b16 v[54:55], v27 offset:1024
    s_lshl_b32 s30, s42, 7
    s_add_u32 m0, s28, 98304
    s_nop 0
    buffer_load_dwordx4 v8, s[12:15], s30 offen lds
    s_add_u32 m0, s28, 99328
    s_nop 0
    buffer_load_dwordx4 v9, s[12:15], s30 offen lds
    s_add_u32 m0, s28, 100352
    s_nop 0
    buffer_load_dwordx4 v10, s[12:15], s30 offen lds
    s_add_u32 m0, s28, 101376
    s_nop 0
    buffer_load_dwordx4 v11, s[12:15], s30 offen lds
    s_mul_i32 s30, s42, 245760
    s_add_u32 m0, s29, 98304
    s_nop 0
    buffer_load_dwordx4 v12, s[16:19], s30 offen lds
    s_add_u32 m0, s29, 99328
    s_nop 0
    buffer_load_dwordx4 v13, s[16:19], s30 offen lds
    s_add_u32 s42, s42, 1
    s_cmp_eq_u32 s42, 10
    s_cselect_b32 s42, 0, s42
    ds_read_b128 v[40:43], v15 offset:0
    ds_read_b128 v[44:47], v15 offset:4096
    ds_read_b64_tr_b16 v[56:57], v26 offset:4096
    ds_read_b64_tr_b16 v[58:59], v26 offset:5120
    ds_read_b64_tr_b16 v[60:61], v27 offset:4096
    ds_read_b64_tr_b16 v[62:63], v27 offset:5120
    s_waitcnt lgkmcnt(6)
    v_mfma_f32_32x32x16_bf16 v[64:79], v[32:35], v[48:51], v[64:79]
    v_mfma_f32_32x32x16_bf16 v[80:95], v[32:35], v[52:55], v[80:95]
    v_mfma_f32_32x32x16_bf16 v[96:111], v[36:39], v[48:51], v[96:111]
    v_mfma_f32_32x32x16_bf16 v[112:127], v[36:39], v[52:55], v[112:127]
    ds_read_b128 v[32:35], v16 offset:0
    ds_read_b128 v[36:39], v16 offset:4096
    ds_read_b64_tr_b16 v[48:49], v26 offset:8192
    ds_read_b64_tr_b16 v[50:51], v26 offset:9216
    ds_read_b64_tr_b16 v[52:53], v27 offset:8192
    ds_read_b64_tr_b16 v[54:55], v27 offset:9216
    s_waitcnt lgkmcnt(6)
    v_mfma_f32_32x32x16_bf16 v[64:79], v[40:43], v[56:59], v[64:79]
    v_mfma_f32_32x32x16_bf16 v[80:95], v[40:43], v[60:63], v[80:95]
    v_mfma_f32_32x32x16_bf16 v[96:111], v[44:47], v[56:59], v[96:111]
    v_mfma_f32_32x32x16_bf16 v[112:127], v[44:47], v[60:63], v[112:127]
    ds_read_b128 v[40:43], v17 offset:0
    ds_read_b128 v[44:47], v17 offset:4096
    ds_read_b64_tr_b16 v[56:57], v26 offset:12288
    ds_read_b64_tr_b16 v[58:59], v26 offset:13312
    ds_read_b64_tr_b16 v[60:61], v27 offset:12288
    ds_read_b64_tr_b16 v[62:63], v27 offset:13312
    s_waitcnt lgkmcnt(6)
    v_mfma_f32_32x32x16_bf16 v[64:79], v[32:35], v[48:51], v[64:79]
    v_mfma_f32_32x32x16_bf16 v[80:95], v[32:35], v[52:55], v[80:95]
    v_mfma_f32_32x32x16_bf16 v[96:111], v[36:39], v[48:51], v[96:111]
    v_mfma_f32_32x32x16_bf16 v[112:127], v[36:39], v[52:55], v[112:127]
    s_waitcnt lgkmcnt(0)
    v_mfma_f32_32x32x16_bf16 v[64:79], v[40:43], v[56:59], v[64:79]
    v_mfma_f32_32x32x16_bf16 v[80:95], v[40:43], v[60:63], v[80:95]
    v_mfma_f32_32x32x16_bf16 v[96:111], v[44:47], v[56:59], v[96:111]
    v_mfma_f32_32x32x16_bf16 v[112:127], v[44:47], v[60:63], v[112:127]
    s_waitcnt vmcnt(6)
    s_barrier
    ds_read_b128 v[32:35], v18 offset:0
    ds_read_b128 v[36:39], v18 offset:4096
    ds_read_b64_tr_b16 v[48:49], v28 offset:0
    ds_read_b64_tr_b16 v[50:51], v28 offset:1024
    ds_read_b64_tr_b16 v[52:53], v29 offset:0
    ds_read_b64_tr_b16 v[54:55], v29 offset:1024
    s_lshl_b32 s30, s42, 7
    s_add_u32 m0, s28, 0
    s_nop 0
    buffer_load_dwordx4 v8, s[12:15], s30 offen lds
    s_add_u32 m0, s28, 1024
    s_nop 0
    buffer_load_dwordx4 v9, s[12:15], s30 offen lds
    s_add_u32 m0, s28, 2048
    s_nop 0
    buffer_load_dwordx4 v10, s[12:15], s30 offen lds
    s_add_u32 m0, s28, 3072
    s_nop 0
    buffer_load_dwordx4 v11, s[12:15], s30 offen lds
    s_mul_i32 s30, s42, 245760
    s_add_u32 m0, s29, 0
    s_nop 0
    buffer_load_dwordx4 v12, s[16:19], s30 offen lds
    s_add_u32 m0, s29, 1024
    s_nop 0
    buffer_load_dwordx4 v13, s[16:19], s30 offen lds
    s_add_u32 s42, s42, 1
    s_cmp_eq_u32 s42, 10
    s_cselect_b32 s42, 0, s42
    ds_read_b128 v[40:43], v19 offset:0
    ds_read_b128 v[44:47], v19 offset:4096
    ds_read_b64_tr_b16 v[56:57], v28 offset:4096
    ds_read_b64_tr_b16 v[58:59], v28 offset:5120
    ds_read_b64_tr_b16 v[60:61], v29 offset:4096
    ds_read_b64_tr_b16 v[62:63], v29 offset:5120
    s_waitcnt lgkmcnt(6)
    v_mfma_f32_32x32x16_bf16 v[64:79], v[32:35], v[48:51], v[64:79]
    v_mfma_f32_32x32x16_bf16 v[80:95], v[32:35], v[52:55], v[80:95]
    v_mfma_f32_32x32x16_bf16 v[96:111], v[36:39], v[48:51], v[96:111]
    v_mfma_f32_32x32x16_bf16 v[112:127], v[36:39], v[52:55], v[112:127]
    ds_read_b128 v[32:35], v20 offset:0
    ds_read_b128 v[36:39], v20 offset:4096
    ds_read_b64_tr_b16 v[48:49], v28 offset:8192
    ds_read_b64_tr_b16 v[50:51], v28 offset:9216
    ds_read_b64_tr_b16 v[52:53], v29 offset:8192
    ds_read_b64_tr_b16 v[54:55], v29 offset:9216
    s_waitcnt lgkmcnt(6)
    v_mfma_f32_32x32x16_bf16 v[64:79], v[40:43], v[56:59], v[64:79]
    v_mfma_f32_32x32x16_bf16 v[80:95], v[40:43], v[60:63], v[80:95]
    v_mfma_f32_32x32x16_bf16 v[96:111], v[44:47], v[56:59], v[96:111]
    v_mfma_f32_32x32x16_bf16 v[112:127], v[44:47], v[60:63], v[112:127]
    ds_read_b128 v[40:43], v21 offset:0
    ds_read_b128 v[44:47], v21 offset:4096
    ds_read_b64_tr_b16 v[56:57], v28 offset:12288
    ds_read_b64_tr_b16 v[58:59], v28 offset:13312
    ds_read_b64_tr_b16 v[60:61], v29 offset:12288
    ds_read_b64_tr_b16 v[62:63], v29 offset:13312
    s_waitcnt lgkmcnt(6)
    v_mfma_f32_32x32x16_bf16 v[64:79], v[32:35], v[48:51], v[64:79]
    v_mfma_f32_32x32x16_bf16 v[80:95], v[32:35], v[52:55], v[80:95]
    v_mfma_f32_32x32x16_bf16 v[96:111], v[36:39], v[48:51], v[96:111]
    v_mfma_f32_32x32x16_bf16 v[112:127], v[36:39], v[52:55], v[112:127]
    s_waitcnt lgkmcnt(0)
    v_mfma_f32_32x32x16_bf16 v[64:79], v[40:43], v[56:59], v[64:79]
    v_mfma_f32_32x32x16_bf16 v[80:95], v[40:43], v[60:63], v[80:95]
    v_mfma_f32_32x32x16_bf16 v[96:111], v[44:47], v[56:59], v[96:111]
    v_mfma_f32_32x32x16_bf16 v[112:127], v[44:47], v[60:63], v[112:127]
    s_waitcnt vmcnt(6)
    s_barrier
    ds_read_b128 v[32:35], v22 offset:0
    ds_read_b128 v[36:39], v22 offset:4096
    ds_read_b64_tr_b16 v[48:49], v30 offset:0
    ds_read_b64_tr_b16 v[50:51], v30 offset:1024
    ds_read_b64_tr_b16 v[52:53], v31 offset:0
    ds_read_b64_tr_b16 v[54:55], v31 offset:1024
    s_lshl_b32 s30, s42, 7
    s_add_u32 m0, s28, 49152
    s_nop 0
    buffer_load_dwordx4 v8, s[12:15], s30 offen lds
    s_add_u32 m0, s28, 50176
    s_nop 0
    buffer_load_dwordx4 v9, s[12:15], s30 offen lds
    s_add_u32 m0, s28, 51200
    s_nop 0
    buffer_load_dwordx4 v10, s[12:15], s30 offen lds
    s_add_u32 m0, s28, 52224
    s_nop 0
    buffer_load_dwordx4 v11, s[12:15], s30 offen lds
    s_mul_i32 s30, s42, 245760
    s_add_u32 m0, s29, 49152
    s_nop 0
    buffer_load_dwordx4 v12, s[16:19], s30 offen lds
    s_add_u32 m0, s29, 50176
    s_nop 0
    buffer_load_dwordx4 v13, s[16:19], s30 offen lds
    s_add_u32 s42, s42, 1
    s_cmp_eq_u32 s42, 10
    s_cselect_b32 s42, 0, s42
    ds_read_b128 v[40:43], v23 offset:0
    ds_read_b128 v[44:47], v23 offset:4096
    ds_read_b64_tr_b16 v[56:57], v30 offset:4096
    ds_read_b64_tr_b16 v[58:59], v30 offset:5120
    ds_read_b64_tr_b16 v[60:61], v31 offset:4096
    ds_read_b64_tr_b16 v[62:63], v31 offset:5120
    s_waitcnt lgkmcnt(6)
    v_mfma_f32_32x32x16_bf16 v[64:79], v[32:35], v[48:51], v[64:79]
    v_mfma_f32_32x32x16_bf16 v[80:95], v[32:35], v[52:55], v[80:95]
    v_mfma_f32_32x32x16_bf16 v[96:111], v[36:39], v[48:51], v[96:111]
    v_mfma_f32_32x32x16_bf16 v[112:127], v[36:39], v[52:55], v[112:127]
    ds_read_b128 v[32:35], v24 offset:0
    ds_read_b128 v[36:39], v24 offset:4096
    ds_read_b64_tr_b16 v[48:49], v30 offset:8192
    ds_read_b64_tr_b16 v[50:51], v30 offset:9216
    ds_read_b64_tr_b16 v[52:53], v31 offset:8192
    ds_read_b64_tr_b16 v[54:55], v31 offset:9216
    s_waitcnt lgkmcnt(6)
    v_mfma_f32_32x32x16_bf16 v[64:79], v[40:43], v[56:59], v[64:79]
    v_mfma_f32_32x32x16_bf16 v[80:95], v[40:43], v[60:63], v[80:95]
    v_mfma_f32_32x32x16_bf16 v[96:111], v[44:47], v[56:59], v[96:111]
    v_mfma_f32_32x32x16_bf16 v[112:127], v[44:47], v[60:63], v[112:127]
    ds_read_b128 v[40:43], v25 offset:0
    ds_read_b128 v[44:47], v25 offset:4096
    ds_read_b64_tr_b16 v[56:57], v30 offset:12288
    ds_read_b64_tr_b16 v[58:59], v30 offset:13312
    ds_read_b64_tr_b16 v[60:61], v31 offset:12288
    ds_read_b64_tr_b16 v[62:63], v31 offset:13312
    s_waitcnt lgkmcnt(6)
    v_mfma_f32_32x32x16_bf16 v[64:79], v[32:35], v[48:51], v[64:79]
    v_mfma_f32_32x32x16_bf16 v[80:95], v[32:35], v[52:55], v[80:95]
    v_mfma_f32_32x32x16_bf16 v[96:111], v[36:39], v[48:51], v[96:111]
    v_mfma_f32_32x32x16_bf16 v[112:127], v[36:39], v[52:55], v[112:127]
    s_waitcnt lgkmcnt(0)
    v_mfma_f32_32x32x16_bf16 v[64:79], v[40:43], v[56:59], v[64:79]
    v_mfma_f32_32x32x16_bf16 v[80:95], v[40:43], v[60:63], v[80:95]
    v_mfma_f32_32x32x16_bf16 v[96:111], v[44:47], v[56:59], v[96:111]
    v_mfma_f32_32x32x16_bf16 v[112:127], v[44:47], v[60:63], v[112:127]
    s_waitcnt vmcnt(6)
    s_barrier
    ds_read_b128 v[32:35], v14 offset:0
    ds_read_b128 v[36:39], v14 offset:4096
    ds_read_b64_tr_b16 v[48:49], v26 offset:0
    ds_read_b64_tr_b16 v[50:51], v26 offset:1024
    ds_read_b64_tr_b16 v[52:53], v27 offset:0
    ds_read_b64_tr_b16 v[54:55], v27 offset:1024
    s_lshl_b32 s30, s42, 7
    s_add_u32 m0, s28, 98304
    s_nop 0
    buffer_load_dwordx4 v8, s[12:15], s30 offen lds
    s_add_u32 m0, s28, 99328
    s_nop 0
    buffer_load_dwordx4 v9, s[12:15], s30 offen lds
    s_add_u32 m0, s28, 100352
    s_nop 0
    buffer_load_dwordx4 v10, s[12:15], s30 offen lds
    s_add_u32 m0, s28, 101376
    s_nop 0
    buffer_load_dwordx4 v11, s[12:15], s30 offen lds
    s_mul_i32 s30, s42, 245760
    s_add_u32 m0, s29, 98304
    s_nop 0
    buffer_load_dwordx4 v12, s[16:19], s30 offen lds
    s_add_u32 m0, s29, 99328
    s_nop 0
    buffer_load_dwordx4 v13, s[16:19], s30 offen lds
    s_add_u32 s42, s42, 1
    s_cmp_eq_u32 s42, 10
    s_cselect_b32 s42, 0, s42
    ds_read_b128 v[40:43], v15 offset:0
    ds_read_b128 v[44:47], v15 offset:4096
    ds_read_b64_tr_b16 v[56:57], v26 offset:4096
    ds_read_b64_tr_b16 v[58:59], v26 offset:5120
    ds_read_b64_tr_b16 v[60:61], v27 offset:4096
    ds_read_b64_tr_b16 v[62:63], v27 offset:5120
    s_waitcnt lgkmcnt(6)
    v_mfma_f32_32x32x16_bf16 v[64:79], v[32:35], v[48:51], v[64:79]
    v_mfma_f32_32x32x16_bf16 v[80:95], v[32:35], v[52:55], v[80:95]
    v_mfma_f32_32x32x16_bf16 v[96:111], v[36:39], v[48:51], v[96:111]
    v_mfma_f32_32x32x16_bf16 v[112:127], v[36:39], v[52:55], v[112:127]
    ds_read_b128 v[32:35], v16 offset:0
    ds_read_b128 v[36:39], v16 offset:4096
    ds_read_b64_tr_b16 v[48:49], v26 offset:8192
    ds_read_b64_tr_b16 v[50:51], v26 offset:9216
    ds_read_b64_tr_b16 v[52:53], v27 offset:8192
    ds_read_b64_tr_b16 v[54:55], v27 offset:9216
    s_waitcnt lgkmcnt(6)
    v_mfma_f32_32x32x16_bf16 v[64:79], v[40:43], v[56:59], v[64:79]
    v_mfma_f32_32x32x16_bf16 v[80:95], v[40:43], v[60:63], v[80:95]
    v_mfma_f32_32x32x16_bf16 v[96:111], v[44:47], v[56:59], v[96:111]
    v_mfma_f32_32x32x16_bf16 v[112:127], v[44:47], v[60:63], v[112:127]
    ds_read_b128 v[40:43], v17 offset:0
    ds_read_b128 v[44:47], v17 offset:4096
    ds_read_b64_tr_b16 v[56:57], v26 offset:12288
    ds_read_b64_tr_b16 v[58:59], v26 offset:13312
    ds_read_b64_tr_b16 v[60:61], v27 offset:12288
    ds_read_b64_tr_b16 v[62:63], v27 offset:13312
    s_waitcnt lgkmcnt(6)
    v_mfma_f32_32x32x16_bf16 v[64:79], v[32:35], v[48:51], v[64:79]
    v_mfma_f32_32x32x16_bf16 v[80:95], v[32:35], v[52:55], v[80:95]
    v_mfma_f32_32x32x16_bf16 v[96:111], v[36:39], v[48:51], v[96:111]
    v_mfma_f32_32x32x16_bf16 v[112:127], v[36:39], v[52:55], v[112:127]
    s_waitcnt lgkmcnt(0)
    v_mfma_f32_32x32x16_bf16 v[64:79], v[40:43], v[56:59], v[64:79]
    v_mfma_f32_32x32x16_bf16 v[80:95], v[40:43], v[60:63], v[80:95]
    v_mfma_f32_32x32x16_bf16 v[96:111], v[44:47], v[56:59], v[96:111]
    v_mfma_f32_32x32x16_bf16 v[112:127], v[44:47], v[60:63], v[112:127]
    s_waitcnt vmcnt(6)
    s_barrier
    ds_read_b128 v[32:35], v18 offset:0
    ds_read_b128 v[36:39], v18 offset:4096
    ds_read_b64_tr_b16 v[48:49], v28 offset:0
    ds_read_b64_tr_b16 v[50:51], v28 offset:1024
    ds_read_b64_tr_b16 v[52:53], v29 offset:0
    ds_read_b64_tr_b16 v[54:55], v29 offset:1024
    s_lshl_b32 s30, s42, 7
    s_add_u32 m0, s28, 0
    s_nop 0
    buffer_load_dwordx4 v8, s[12:15], s30 offen lds
    s_add_u32 m0, s28, 1024
    s_nop 0
    buffer_load_dwordx4 v9, s[12:15], s30 offen lds
    s_add_u32 m0, s28, 2048
    s_nop 0
    buffer_load_dwordx4 v10, s[12:15], s30 offen lds
    s_add_u32 m0, s28, 3072
    s_nop 0
    buffer_load_dwordx4 v11, s[12:15], s30 offen lds
    s_mul_i32 s30, s42, 245760
    s_add_u32 m0, s29, 0
    s_nop 0
    buffer_load_dwordx4 v12, s[16:19], s30 offen lds
    s_add_u32 m0, s29, 1024
    s_nop 0
    buffer_load_dwordx4 v13, s[16:19], s30 offen lds
    s_add_u32 s42, s42, 1
    s_cmp_eq_u32 s42, 10
    s_cselect_b32 s42, 0, s42
    ds_read_b128 v[40:43], v19 offset:0
    ds_read_b128 v[44:47], v19 offset:4096
    ds_read_b64_tr_b16 v[56:57], v28 offset:4096
    ds_read_b64_tr_b16 v[58:59], v28 offset:5120
    ds_read_b64_tr_b16 v[60:61], v29 offset:4096
    ds_read_b64_tr_b16 v[62:63], v29 offset:5120
    s_waitcnt lgkmcnt(6)
    v_mfma_f32_32x32x16_bf16 v[64:79], v[32:35], v[48:51], v[64:79]
    v_mfma_f32_32x32x16_bf16 v[80:95], v[32:35], v[52:55], v[80:95]
    v_mfma_f32_32x32x16_bf16 v[96:111], v[36:39], v[48:51], v[96:111]
    v_mfma_f32_32x32x16_bf16 v[112:127], v[36:39], v[52:55], v[112:127]
    ds_read_b128 v[32:35], v20 offset:0
    ds_read_b128 v[36:39], v20 offset:4096
    ds_read_b64_tr_b16 v[48:49], v28 offset:8192
    ds_read_b64_tr_b16 v[50:51], v28 offset:9216
    ds_read_b64_tr_b16 v[52:53], v29 offset:8192
    ds_read_b64_tr_b16 v[54:55], v29 offset:9216
    s_waitcnt lgkmcnt(6)
    v_mfma_f32_32x32x16_bf16 v[64:79], v[40:43], v[56:59], v[64:79]
    v_mfma_f32_32x32x16_bf16 v[80:95], v[40:43], v[60:63], v[80:95]
    v_mfma_f32_32x32x16_bf16 v[96:111], v[44:47], v[56:59], v[96:111]
    v_mfma_f32_32x32x16_bf16 v[112:127], v[44:47], v[60:63], v[112:127]
    ds_read_b128 v[40:43], v21 offset:0
    ds_read_b128 v[44:47], v21 offset:4096
    ds_read_b64_tr_b16 v[56:57], v28 offset:12288
    ds_read_b64_tr_b16 v[58:59], v28 offset:13312
    ds_read_b64_tr_b16 v[60:61], v29 offset:12288
    ds_read_b64_tr_b16 v[62:63], v29 offset:13312
    s_waitcnt lgkmcnt(6)
    v_mfma_f32_32x32x16_bf16 v[64:79], v[32:35], v[48:51], v[64:79]
    v_mfma_f32_32x32x16_bf16 v[80:95], v[32:35], v[52:55], v[80:95]
    v_mfma_f32_32x32x16_bf16 v[96:111], v[36:39], v[48:51], v[96:111]
    v_mfma_f32_32x32x16_bf16 v[112:127], v[36:39], v[52:55], v[112:127]
    s_waitcnt lgkmcnt(0)
    v_mfma_f32_32x32x16_bf16 v[64:79], v[40:43], v[56:59], v[64:79]
    v_mfma_f32_32x32x16_bf16 v[80:95], v[40:43], v[60:63], v[80:95]
    v_mfma_f32_32x32x16_bf16 v[96:111], v[44:47], v[56:59], v[96:111]
    v_mfma_f32_32x32x16_bf16 v[112:127], v[44:47], v[60:63], v[112:127]
    s_waitcnt vmcnt(6)
    s_barrier
    ds_read_b128 v[32:35], v22 offset:0
    ds_read_b128 v[36:39], v22 offset:4096
    ds_read_b64_tr_b16 v[48:49], v30 offset:0
    ds_read_b64_tr_b16 v[50:51], v30 offset:1024
    ds_read_b64_tr_b16 v[52:53], v31 offset:0
    ds_read_b64_tr_b16 v[54:55], v31 offset:1024
    ds_read_b128 v[40:43], v23 offset:0
    ds_read_b128 v[44:47], v23 offset:4096
    ds_read_b64_tr_b16 v[56:57], v30 offset:4096
    ds_read_b64_tr_b16 v[58:59], v30 offset:5120
    ds_read_b64_tr_b16 v[60:61], v31 offset:4096
    ds_read_b64_tr_b16 v[62:63], v31 offset:5120
    s_waitcnt lgkmcnt(6)
    v_mfma_f32_32x32x16_bf16 v[64:79], v[32:35], v[48:51], v[64:79]
    v_mfma_f32_32x32x16_bf16 v[80:95], v[32:35], v[52:55], v[80:95]
    v_mfma_f32_32x32x16_bf16 v[96:111], v[36:39], v[48:51], v[96:111]
    v_mfma_f32_32x32x16_bf16 v[112:127], v[36:39], v[52:55], v[112:127]
    ds_read_b128 v[32:35], v24 offset:0
    ds_read_b128 v[36:39], v24 offset:4096
    ds_read_b64_tr_b16 v[48:49], v30 offset:8192
    ds_read_b64_tr_b16 v[50:51], v30 offset:9216
    ds_read_b64_tr_b16 v[52:53], v31 offset:8192
    ds_read_b64_tr_b16 v[54:55], v31 offset:9216
    s_waitcnt lgkmcnt(6)
    v_mfma_f32_32x32x16_bf16 v[64:79], v[40:43], v[56:59], v[64:79]
    v_mfma_f32_32x32x16_bf16 v[80:95], v[40:43], v[60:63], v[80:95]
    v_mfma_f32_32x32x16_bf16 v[96:111], v[44:47], v[56:59], v[96:111]
    v_mfma_f32_32x32x16_bf16 v[112:127], v[44:47], v[60:63], v[112:127]
    ds_read_b128 v[40:43], v25 offset:0
    ds_read_b128 v[44:47], v25 offset:4096
    ds_read_b64_tr_b16 v[56:57], v30 offset:12288
    ds_read_b64_tr_b16 v[58:59], v30 offset:13312
    ds_read_b64_tr_b16 v[60:61], v31 offset:12288
    ds_read_b64_tr_b16 v[62:63], v31 offset:13312
    s_waitcnt lgkmcnt(6)
    v_mfma_f32_32x32x16_bf16 v[64:79], v[32:35], v[48:51], v[64:79]
    v_mfma_f32_32x32x16_bf16 v[80:95], v[32:35], v[52:55], v[80:95]
    v_mfma_f32_32x32x16_bf16 v[96:111], v[36:39], v[48:51], v[96:111]
    v_mfma_f32_32x32x16_bf16 v[112:127], v[36:39], v[52:55], v[112:127]
    s_waitcnt lgkmcnt(0)
    v_mfma_f32_32x32x16_bf16 v[64:79], v[40:43], v[56:59], v[64:79]
    v_mfma_f32_32x32x16_bf16 v[80:95], v[40:43], v[60:63], v[80:95]
    v_mfma_f32_32x32x16_bf16 v[96:111], v[44:47], v[56:59], v[96:111]
    v_mfma_f32_32x32x16_bf16 v[112:127], v[44:47], v[60:63], v[112:127]
    s_waitcnt vmcnt(0)
    s_barrier
    ds_read_b128 v[32:35], v14 offset:0
    ds_read_b128 v[36:39], v14 offset:4096
    ds_read_b64_tr_b16 v[48:49], v26 offset:0
    ds_read_b64_tr_b16 v[50:51], v26 offset:1024
    ds_read_b64_tr_b16 v[52:53], v27 offset:0
    ds_read_b64_tr_b16 v[54:55], v27 offset:1024
    ds_read_b128 v[40:43], v15 offset:0
    ds_read_b128 v[44:47], v15 offset:4096
    ds_read_b64_tr_b16 v[56:57], v26 offset:4096
    ds_read_b64_tr_b16 v[58:59], v26 offset:5120
    ds_read_b64_tr_b16 v[60:61], v27 offset:4096
    ds_read_b64_tr_b16 v[62:63], v27 offset:5120
    s_waitcnt lgkmcnt(6)
    v_mfma_f32_32x32x16_bf16 v[64:79], v[32:35], v[48:51], v[64:79]
    v_mfma_f32_32x32x16_bf16 v[80:95], v[32:35], v[52:55], v[80:95]
    v_mfma_f32_32x32x16_bf16 v[96:111], v[36:39], v[48:51], v[96:111]
    v_mfma_f32_32x32x16_bf16 v[112:127], v[36:39], v[52:55], v[112:127]
    ds_read_b128 v[32:35], v16 offset:0
    ds_read_b128 v[36:39], v16 offset:4096
    ds_read_b64_tr_b16 v[48:49], v26 offset:8192
    ds_read_b64_tr_b16 v[50:51], v26 offset:9216
    ds_read_b64_tr_b16 v[52:53], v27 offset:8192
    ds_read_b64_tr_b16 v[54:55], v27 offset:9216
    s_waitcnt lgkmcnt(6)
    v_mfma_f32_32x32x16_bf16 v[64:79], v[40:43], v[56:59], v[64:79]
    v_mfma_f32_32x32x16_bf16 v[80:95], v[40:43], v[60:63], v[80:95]
    v_mfma_f32_32x32x16_bf16 v[96:111], v[44:47], v[56:59], v[96:111]
    v_mfma_f32_32x32x16_bf16 v[112:127], v[44:47], v[60:63], v[112:127]
    ds_read_b128 v[40:43], v17 offset:0
    ds_read_b128 v[44:47], v17 offset:4096
    ds_read_b64_tr_b16 v[56:57], v26 offset:12288
    ds_read_b64_tr_b16 v[58:59], v26 offset:13312
    ds_read_b64_tr_b16 v[60:61], v27 offset:12288
    ds_read_b64_tr_b16 v[62:63], v27 offset:13312
    s_waitcnt lgkmcnt(6)
    v_mfma_f32_32x32x16_bf16 v[64:79], v[32:35], v[48:51], v[64:79]
    v_mfma_f32_32x32x16_bf16 v[80:95], v[32:35], v[52:55], v[80:95]
    v_mfma_f32_32x32x16_bf16 v[96:111], v[36:39], v[48:51], v[96:111]
    v_mfma_f32_32x32x16_bf16 v[112:127], v[36:39], v[52:55], v[112:127]
    s_waitcnt lgkmcnt(0)
    v_mfma_f32_32x32x16_bf16 v[64:79], v[40:43], v[56:59], v[64:79]
    v_mfma_f32_32x32x16_bf16 v[80:95], v[40:43], v[60:63], v[80:95]
    v_mfma_f32_32x32x16_bf16 v[96:111], v[44:47], v[56:59], v[96:111]
    v_mfma_f32_32x32x16_bf16 v[112:127], v[44:47], v[60:63], v[112:127]
    s_nop 15
    s_nop 15
    v_and_b32 v2, 63, v0
    v_and_b32 v3, 31, v2
    v_lshrrev_b32 v4, 5, v2
    s_lshl_b32 s31, s26, 7
    s_add_u32 s31, s31, s35
    s_sub_u32 s31, s31, 1280
    v_add_u32 v3, s31, v3
    s_lshl_b32 s32, s25, 8
    s_add_u32 s32, s32, s34
    s_lshr_b32 s32, s32, 5
    s_mul_i32 s32, s32, 3072
    s_add_u32 s32, s32, 12584448
    v_mul_u32_u24 v5, 384, v4
    v_add_u32 v5, s32, v5
    s_mov_b32 s33, 3277
    s_mov_b32 s31, 196608
    v_mov_b32 v32, 0x3f803f80
    v_mov_b32 v33, 0x3f803f80
    v_mov_b32 v34, 0x3f803f80
    v_mov_b32 v35, 0x3f803f80
    v_add_u32 v1, 0, v3
    v_mul_u32_u24 v6, s33, v1
    v_lshrrev_b32 v6, 16, v6
    v_mul_u32_u24 v7, 20, v6
    v_sub_u32 v7, v1, v7
    v_mul_u32_u24 v6, s31, v6
    v_lshl_add_u32 v6, v7, 4, v6
    v_add_u32 v6, v6, v5
    v_cmp_eq_u32 vcc, 19, v7
    v_cvt_pk_bf16_f32 v64, v64, v65
    v_cvt_pk_bf16_f32 v65, v66, v67
    v_cvt_pk_bf16_f32 v66, v68, v69
    v_cvt_pk_bf16_f32 v67, v70, v71
    v_cvt_pk_bf16_f32 v68, v72, v73
    v_cvt_pk_bf16_f32 v69, v74, v75
    v_cvt_pk_bf16_f32 v70, v76, v77
    v_cvt_pk_bf16_f32 v71, v78, v79
    buffer_store_dwordx4 v[64:67], v6, s[20:23], 0 offen offset:0
    buffer_store_dwordx4 v[68:71], v6, s[20:23], 0 offen offset:768
    v_cvt_pk_bf16_f32 v96, v96, v97
    v_cvt_pk_bf16_f32 v97, v98, v99
    v_cvt_pk_bf16_f32 v98, v100, v101
    v_cvt_pk_bf16_f32 v99, v102, v103
    v_cvt_pk_bf16_f32 v100, v104, v105
    v_cvt_pk_bf16_f32 v101, v106, v107
    v_cvt_pk_bf16_f32 v102, v108, v109
    v_cvt_pk_bf16_f32 v103, v110, v111
    buffer_store_dwordx4 v[96:99], v6, s[20:23], 0 offen offset:3072
    buffer_store_dwordx4 v[100:103], v6, s[20:23], 0 offen offset:3840
    s_and_saveexec_b64 s[38:39], vcc
    s_cbranch_execz qkv_kernel_vo_0
    buffer_store_dwordx4 v[32:35], v6, s[20:23], 0 offen offset:16
    buffer_store_dwordx4 v[32:35], v6, s[20:23], 0 offen offset:784
    buffer_store_dwordx4 v[32:35], v6, s[20:23], 0 offen offset:3088
    buffer_store_dwordx4 v[32:35], v6, s[20:23], 0 offen offset:3856
qkv_kernel_vo_0:
    s_mov_b64 exec, s[38:39]
    v_add_u32 v1, 32, v3
    v_mul_u32_u24 v6, s33, v1
    v_lshrrev_b32 v6, 16, v6
    v_mul_u32_u24 v7, 20, v6
    v_sub_u32 v7, v1, v7
    v_mul_u32_u24 v6, s31, v6
    v_lshl_add_u32 v6, v7, 4, v6
    v_add_u32 v6, v6, v5
    v_cmp_eq_u32 vcc, 19, v7
    v_cvt_pk_bf16_f32 v80, v80, v81
    v_cvt_pk_bf16_f32 v81, v82, v83
    v_cvt_pk_bf16_f32 v82, v84, v85
    v_cvt_pk_bf16_f32 v83, v86, v87
    v_cvt_pk_bf16_f32 v84, v88, v89
    v_cvt_pk_bf16_f32 v85, v90, v91
    v_cvt_pk_bf16_f32 v86, v92, v93
    v_cvt_pk_bf16_f32 v87, v94, v95
    buffer_store_dwordx4 v[80:83], v6, s[20:23], 0 offen offset:0
    buffer_store_dwordx4 v[84:87], v6, s[20:23], 0 offen offset:768
    v_cvt_pk_bf16_f32 v112, v112, v113
    v_cvt_pk_bf16_f32 v113, v114, v115
    v_cvt_pk_bf16_f32 v114, v116, v117
    v_cvt_pk_bf16_f32 v115, v118, v119
    v_cvt_pk_bf16_f32 v116, v120, v121
    v_cvt_pk_bf16_f32 v117, v122, v123
    v_cvt_pk_bf16_f32 v118, v124, v125
    v_cvt_pk_bf16_f32 v119, v126, v127
    buffer_store_dwordx4 v[112:115], v6, s[20:23], 0 offen offset:3072
    buffer_store_dwordx4 v[116:119], v6, s[20:23], 0 offen offset:3840
    s_and_saveexec_b64 s[38:39], vcc
    s_cbranch_execz qkv_kernel_vo_1
    buffer_store_dwordx4 v[32:35], v6, s[20:23], 0 offen offset:16
    buffer_store_dwordx4 v[32:35], v6, s[20:23], 0 offen offset:784
    buffer_store_dwordx4 v[32:35], v6, s[20:23], 0 offen offset:3088
    buffer_store_dwordx4 v[32:35], v6, s[20:23], 0 offen offset:3856
qkv_kernel_vo_1:
    s_mov_b64 exec, s[38:39]
qkv_kernel_done:
qkv_kernel_done2:
    s_endpgm
.globl attn_kernel
.p2align 8
.type attn_kernel,@function
attn_kernel:
    s_cmp_ge_u32 s2, 256
    s_cbranch_scc1 attn_kernel_done2
    s_load_dwordx2 s[4:5], s[0:1], 64
    v_lshrrev_b32 v1, 6, v0
    v_and_b32 v0, 63, v0
    s_and_b32 s30, s2, 7
    v_readfirstlane_b32 s20, v1
    s_lshr_b32 s31, s2, 3
    s_lshl_b32 s23, s30, 2
    s_lshr_b32 s30, s31, 3
    s_add_u32 s23, s23, s30
    s_and_b32 s24, s31, 7
    s_and_b32 s21, s20, 3
    s_lshr_b32 s22, s20, 2
    s_mov_b32 s29, 0x42700000
    s_waitcnt lgkmcnt(0)
    s_mul_i32 s30, s23, 196608
    s_add_u32 s30, s30, 12582912
    s_add_u32 s8, s4, s30
    s_addc_u32 s9, s5, 0
    s_mov_b32 s10, 196608
    s_mov_b32 s11, 0x00020000
    s_mul_i32 s30, s22, 98304
    s_mul_i32 s31, s21, 3072
    s_add_u32 s30, s30, s31
    v_lshlrev_b32 v2, 4, v0
    v_add_u32 v2, s30, v2
    s_mul_i32 s26, s22, 12288
    s_add_u32 s26, s26, s31
    s_mov_b32 s32, s26
    s_add_u32 m0, s32, 0
    s_mov_b32 s30, 0
    buffer_load_dwordx4 v2, s[8:11], s30 offen lds
    s_add_u32 m0, s32, 1024
    s_mov_b32 s30, 1024
    buffer_load_dwordx4 v2, s[8:11], s30 offen lds
    s_add_u32 m0, s32, 2048
    s_mov_b32 s30, 2048
    buffer_load_dwordx4 v2, s[8:11], s30 offen lds
    s_add_u32 s12, s4, 8388608
    s_addc_u32 s13, s5, 0
    s_mov_b32 s14, 2621440
    s_mov_b32 s15, 0x00020000
    s_add_u32 s16, s4, 25165824
    s_addc_u32 s17, s5, 0
    s_mov_b32 s18, 2621440
    s_mov_b32 s19, 0x00020000
    s_load_dwordx2 s[52:53], s[0:1], 16
    s_load_dwordx2 s[56:57], s[0:1], 40
    v_min_u32 v1, 24, v0
    v_lshlrev_b32 v1, 7, v1
    s_mov_b32 s54, 819200
    s_mov_b32 s55, 0x00020000
    s_mov_b32 s58, 819200
    s_mov_b32 s59, 0x00020000
    v_mov_b32 v195, v1
    s_mul_i32 s51, s2, 3200
    s_waitcnt lgkmcnt(0)
    v_and_b32 v11, 31, v0
    v_lshrrev_b32 v12, 5, v0
    s_lshl_b32 s30, s24, 8
    s_lshl_b32 s31, s21, 6
    s_add_u32 s30, s30, s31
    v_add_u32 v13, s30, v11
    s_mul_i32 s30, s23, 81920
    v_mov_b32 v14, s30
    v_mad_u32_u24 v13, v13, 40, v14
    v_lshl_add_u32 v14, v12, 4, v13
    v_add_u32 v15, 1280, v14
    v_add_u32 v1, 1280, v13
    buffer_load_dwordx2 v[16:17], v14, s[12:15], 0 offen
    buffer_load_dwordx2 v[18:19], v14, s[12:15], 0 offen offset:8
    buffer_load_dwordx2 v[20:21], v13, s[12:15], 0 offen offset:32
    buffer_load_dwordx2 v[24:25], v15, s[12:15], 0 offen
    buffer_load_dwordx2 v[26:27], v15, s[12:15], 0 offen offset:8
    buffer_load_dwordx2 v[28:29], v1, s[12:15], 0 offen offset:32
    s_mov_b32 s36, s4
    s_mov_b32 s37, s5
    s_mov_b32 s38, 7864320
    s_mov_b32 s39, 0x00020000
    s_add_u32 s40, s4, 20971520
    s_addc_u32 s41, s5, 0
    s_mov_b32 s42, 2621440
    s_mov_b32 s43, 0x00020000
    s_lshl_b32 s44, s2, 3
    s_mul_i32 s30, s22, 12288
    v_lshlrev_b32 v3, 4, v0
    v_add_u32 v3, s30, v3
    v_lshlrev_b32 v4, 4, v11
    v_add_u32 v4, s30, v4
    v_add_u32 v4, 1024, v4
    v_min_u32 v5, 23, v11
    v_lshlrev_b32 v5, 4, v5
    v_mul_u32_u24 v14, 384, v12
    v_add_u32 v5, v5, v14
    v_add_u32 v5, s30, v5
    v_add_u32 v5, 1536, v5
    s_mov_b32 s50, 0
attn_kernel_restart:
    s_lshl_b32 s45, s20, 1
    s_cmp_eq_u32 s50, 0
    s_cbranch_scc1 attn_kernel_skip_s0
    s_add_u32 m0, s32, 0
    s_mov_b32 s30, 0
    buffer_load_dwordx4 v2, s[8:11], s30 offen lds
    s_add_u32 m0, s32, 1024
    s_mov_b32 s30, 1024
    buffer_load_dwordx4 v2, s[8:11], s30 offen lds
    s_add_u32 m0, s32, 2048
    s_mov_b32 s30, 2048
    buffer_load_dwordx4 v2, s[8:11], s30 offen lds
attn_kernel_skip_s0:
    s_add_u32 m0, s32, 24576
    s_mov_b32 s30, 12288
    buffer_load_dwordx4 v2, s[8:11], s30 offen lds
    s_add_u32 m0, s32, 25600
    s_mov_b32 s30, 13312
    buffer_load_dwordx4 v2, s[8:11], s30 offen lds
    s_add_u32 m0, s32, 26624
    s_mov_b32 s30, 14336
    buffer_load_dwordx4 v2, s[8:11], s30 offen lds
    v_mov_b32 v96, 0
    v_mov_b32 v97, 0
    v_mov_b32 v98, 0
    v_mov_b32 v99, 0
    v_mov_b32 v100, 0
    v_mov_b32 v101, 0
    v_mov_b32 v102, 0
    v_mov_b32 v103, 0
    v_mov_b32 v104, 0
    v_mov_b32 v105, 0
    v_mov_b32 v106, 0
    v_mov_b32 v107, 0
    v_mov_b32 v108, 0
    v_mov_b32 v109, 0
    v_mov_b32 v110, 0
    v_mov_b32 v111, 0
    v_mov_b32 v112, 0
    v_mov_b32 v113, 0
    v_mov_b32 v114, 0
    v_mov_b32 v115, 0
    v_mov_b32 v116, 0
    v_mov_b32 v117, 0
    v_mov_b32 v118, 0
    v_mov_b32 v119, 0
    v_mov_b32 v120, 0
    v_mov_b32 v121, 0
    v_mov_b32 v122, 0
    v_mov_b32 v123, 0
    v_mov_b32 v124, 0
    v_mov_b32 v125, 0
    v_mov_b32 v126, 0
    v_mov_b32 v127, 0
    s_waitcnt vmcnt(3)
    v_cmp_gt_u32 vcc, 32, v0
    s_nop 1
    v_cndmask_b32 v20, 0, v20, vcc
    v_cndmask_b32 v21, 0, v21, vcc
    v_mov_b32 v22, 0
    v_mov_b32 v23, 0
    v_cndmask_b32 v28, 0, v28, vcc
    v_cndmask_b32 v29, 0, v29, vcc
    v_mov_b32 v30, 0
    v_mov_b32 v31, 0
    s_waitcnt vmcnt(3)
    s_barrier
    ds_read_b128 v[32:35], v3
    ds_read_b128 v[36:39], v4
    ds_read_b128 v[40:43], v3 offset:3072
    ds_read_b128 v[44:47], v4 offset:3072
    v_mov_b32 v56, 0
    v_mov_b32 v176, 0
    v_mov_b32 v57, 0
    v_mov_b32 v177, 0
    v_mov_b32 v58, 0
    v_mov_b32 v178, 0
    v_mov_b32 v59, 0
    v_mov_b32 v179, 0
    v_mov_b32 v60, 0
    v_mov_b32 v180, 0
    v_mov_b32 v61, 0
    v_mov_b32 v181, 0
    v_mov_b32 v62, 0
    v_mov_b32 v182, 0
    v_mov_b32 v63, 0
    v_mov_b32 v183, 0
    s_waitcnt lgkmcnt(2)
    v_mfma_f32_32x32x16_bf16 v[128:143], v[32:35], v[16:19], v[96:111]
    v_mfma_f32_32x32x16_bf16 v[128:143], v[36:39], v[20:23], v[128:143]
    v_mfma_f32_32x32x16_bf16 v[160:175], v[32:35], v[24:27], v[112:127]
    v_mfma_f32_32x32x16_bf16 v[160:175], v[36:39], v[28:31], v[160:175]
    s_nop 15
    s_nop 15
    v_max3_f32 v11, v128, v129, v130
    v_max3_f32 v11, v11, v131, v132
    v_max3_f32 v11, v11, v133, v134
    v_max3_f32 v11, v11, v135, v136
    v_max3_f32 v11, v11, v137, v138
    v_max3_f32 v11, v11, v139, v140
    v_max3_f32 v11, v11, v141, v142
    v_max_f32 v11, v11, v143
    v_mov_b32 v12, v11
    s_nop 1
    v_permlane32_swap_b32 v11, v12
    v_max_f32 v11, v11, v12
    v_sub_f32 v128, v128, v11
    v_sub_f32 v129, v129, v11
    v_sub_f32 v130, v130, v11
    v_sub_f32 v131, v131, v11
    v_sub_f32 v132, v132, v11
    v_sub_f32 v133, v133, v11
    v_sub_f32 v134, v134, v11
    v_sub_f32 v135, v135, v11
    v_sub_f32 v136, v136, v11
    v_sub_f32 v137, v137, v11
    v_sub_f32 v138, v138, v11
    v_sub_f32 v139, v139, v11
    v_sub_f32 v140, v140, v11
    v_sub_f32 v141, v141, v11
    v_sub_f32 v142, v142, v11
    v_sub_f32 v143, v143, v11
    v_sub_f32 v64, 0, v11
    v_sub_f32 v65, 0, v11
    v_sub_f32 v66, 0, v11
    v_sub_f32 v67, 0, v11
    v_sub_f32 v68, 0, v11
    v_sub_f32 v69, 0, v11
    v_sub_f32 v70, 0, v11
    v_sub_f32 v71, 0, v11
    v_sub_f32 v72, 0, v11
    v_sub_f32 v73, 0, v11
    v_sub_f32 v74, 0, v11
    v_sub_f32 v75, 0, v11
    v_sub_f32 v76, 0, v11
    v_sub_f32 v77, 0, v11
    v_sub_f32 v78, 0, v11
    v_sub_f32 v79, 0, v11
    v_max3_f32 v11, v160, v161, v162
    v_max3_f32 v11, v11, v163, v164
    v_max3_f32 v11, v11, v165, v166
    v_max3_f32 v11, v11, v167, v168
    v_max3_f32 v11, v11, v169, v170
    v_max3_f32 v11, v11, v171, v172
    v_max3_f32 v11, v11, v173, v174
    v_max_f32 v11, v11, v175
    v_mov_b32 v12, v11
    s_nop 1
    v_permlane32_swap_b32 v11, v12
    v_max_f32 v11, v11, v12
    v_sub_f32 v160, v160, v11
    v_sub_f32 v161, v161, v11
    v_sub_f32 v162, v162, v11
    v_sub_f32 v163, v163, v11
    v_sub_f32 v164, v164, v11
    v_sub_f32 v165, v165, v11
    v_sub_f32 v166, v166, v11
    v_sub_f32 v167, v167, v11
    v_sub_f32 v168, v168, v11
    v_sub_f32 v169, v169, v11
    v_sub_f32 v170, v170, v11
    v_sub_f32 v171, v171, v11
    v_sub_f32 v172, v172, v11
    v_sub_f32 v173, v173, v11
    v_sub_f32 v174, v174, v11
    v_sub_f32 v175, v175, v11
    v_sub_f32 v80, 0, v11
    v_sub_f32 v81, 0, v11
    v_sub_f32 v82, 0, v11
    v_sub_f32 v83, 0, v11
    v_sub_f32 v84, 0, v11
    v_sub_f32 v85, 0, v11
    v_sub_f32 v86, 0, v11
    v_sub_f32 v87, 0, v11
    v_sub_f32 v88, 0, v11
    v_sub_f32 v89, 0, v11
    v_sub_f32 v90, 0, v11
    v_sub_f32 v91, 0, v11
    v_sub_f32 v92, 0, v11
    v_sub_f32 v93, 0, v11
    v_sub_f32 v94, 0, v11
    v_sub_f32 v95, 0, v11
    s_mov_b32 s25, 0
    s_add_u32 s26, s32, 49152
    s_mov_b32 s27, 24576
    s_mov_b32 s28, 8
    v_mov_b32 v6, v3
    v_mov_b32 v7, v4
    v_mov_b32 v8, v5
    v_add_u32 v9, 24576, v3
    v_add_u32 v10, 24576, v4
    s_mov_b64 vcc, 0
    s_cmp_lg_u32 s50, 0
    s_cbranch_scc1 attn_kernel_safe
attn_kernel_loopf:
    ds_read_b128 v[48:51], v8 offset:0
    ds_read_b128 v[52:55], v8 offset:768
    v_exp_f32 v128, v128
    v_exp_f32 v129, v129
    v_mfma_f32_32x32x16_bf16 v[112:127], v[56:59], v[176:179], v[112:127]
    v_exp_f32 v130, v130
    v_exp_f32 v131, v131
    v_exp_f32 v132, v132
    v_cvt_pk_bf16_f32 v128, v128, v129
    v_mfma_f32_32x32x16_bf16 v[112:127], v[60:63], v[180:183], v[112:127]
    v_exp_f32 v133, v133
    v_exp_f32 v134, v134
    v_cvt_pk_bf16_f32 v129, v130, v131
    v_exp_f32 v135, v135
    s_waitcnt lgkmcnt(2)
    v_mfma_f32_32x32x16_bf16 v[144:159], v[40:43], v[16:19], v[64:79]
    v_exp_f32 v136, v136
    v_cvt_pk_bf16_f32 v130, v132, v133
    v_exp_f32 v137, v137
    v_exp_f32 v138, v138
    v_cvt_pk_bf16_f32 v131, v134, v135
    v_exp_f32 v139, v139
    v_mfma_f32_32x32x16_bf16 v[144:159], v[44:47], v[20:23], v[144:159]
    v_exp_f32 v140, v140
    v_cvt_pk_bf16_f32 v132, v136, v137
    v_exp_f32 v141, v141
    v_exp_f32 v142, v142
    v_cvt_pk_bf16_f32 v133, v138, v139
    v_exp_f32 v143, v143
    v_cvt_pk_bf16_f32 v134, v140, v141
    v_cvt_pk_bf16_f32 v135, v142, v143
    ds_read_b128 v[32:35], v6 offset:6144
    ds_read_b128 v[36:39], v7 offset:6144
    v_exp_f32 v160, v160
    v_exp_f32 v161, v161
    s_waitcnt lgkmcnt(2)
    v_mfma_f32_32x32x16_bf16 v[96:111], v[48:51], v[128:131], v[96:111]
    v_exp_f32 v162, v162
    v_exp_f32 v163, v163
    v_exp_f32 v164, v164
    v_cvt_pk_bf16_f32 v160, v160, v161
    v_mfma_f32_32x32x16_bf16 v[96:111], v[52:55], v[132:135], v[96:111]
    v_exp_f32 v165, v165
    v_exp_f32 v166, v166
    v_cvt_pk_bf16_f32 v161, v162, v163
    v_exp_f32 v167, v167
    v_mfma_f32_32x32x16_bf16 v[176:191], v[40:43], v[24:27], v[80:95]
    v_exp_f32 v168, v168
    v_cvt_pk_bf16_f32 v162, v164, v165
    v_exp_f32 v169, v169
    v_exp_f32 v170, v170
    v_cvt_pk_bf16_f32 v163, v166, v167
    v_exp_f32 v171, v171
    v_mfma_f32_32x32x16_bf16 v[176:191], v[44:47], v[28:31], v[176:191]
    v_exp_f32 v172, v172
    v_cvt_pk_bf16_f32 v164, v168, v169
    v_exp_f32 v173, v173
    v_exp_f32 v174, v174
    v_cvt_pk_bf16_f32 v165, v170, v171
    v_exp_f32 v175, v175
    v_cvt_pk_bf16_f32 v166, v172, v173
    v_cvt_pk_bf16_f32 v167, v174, v175
    ds_read_b128 v[56:59], v8 offset:3072
    ds_read_b128 v[60:63], v8 offset:3840
    v_exp_f32 v144, v144
    v_exp_f32 v145, v145
    v_mfma_f32_32x32x16_bf16 v[112:127], v[48:51], v[160:163], v[112:127]
    v_exp_f32 v146, v146
    v_exp_f32 v147, v147
    v_exp_f32 v148, v148
    v_cvt_pk_bf16_f32 v144, v144, v145
    v_mfma_f32_32x32x16_bf16 v[112:127], v[52:55], v[164:167], v[112:127]
    v_exp_f32 v149, v149
    v_exp_f32 v150, v150
    v_cvt_pk_bf16_f32 v145, v146, v147
    v_exp_f32 v151, v151
    s_waitcnt lgkmcnt(2)
    v_mfma_f32_32x32x16_bf16 v[128:143], v[32:35], v[16:19], v[64:79]
    v_exp_f32 v152, v152
    v_cvt_pk_bf16_f32 v146, v148, v149
    v_exp_f32 v153, v153
    v_exp_f32 v154, v154
    v_cvt_pk_bf16_f32 v147, v150, v151
    v_exp_f32 v155, v155
    v_mfma_f32_32x32x16_bf16 v[128:143], v[36:39], v[20:23], v[128:143]
    v_exp_f32 v156, v156
    v_cvt_pk_bf16_f32 v148, v152, v153
    v_exp_f32 v157, v157
    v_exp_f32 v158, v158
    v_cvt_pk_bf16_f32 v149, v154, v155
    v_exp_f32 v159, v159
    v_cvt_pk_bf16_f32 v150, v156, v157
    v_cvt_pk_bf16_f32 v151, v158, v159
    ds_read_b128 v[40:43], v6 offset:9216
    ds_read_b128 v[44:47], v7 offset:9216
    v_exp_f32 v176, v176
    v_exp_f32 v177, v177
    s_waitcnt lgkmcnt(2)
    v_mfma_f32_32x32x16_bf16 v[96:111], v[56:59], v[144:147], v[96:111]
    v_exp_f32 v178, v178
    v_exp_f32 v179, v179
    v_exp_f32 v180, v180
    v_cvt_pk_bf16_f32 v176, v176, v177
    v_mfma_f32_32x32x16_bf16 v[96:111], v[60:63], v[148:151], v[96:111]
    v_exp_f32 v181, v181
    v_exp_f32 v182, v182
    v_cvt_pk_bf16_f32 v177, v178, v179
    v_exp_f32 v183, v183
    v_mfma_f32_32x32x16_bf16 v[160:175], v[32:35], v[24:27], v[80:95]
    v_exp_f32 v184, v184
    v_cvt_pk_bf16_f32 v178, v180, v181
    v_exp_f32 v185, v185
    v_exp_f32 v186, v186
    v_cvt_pk_bf16_f32 v179, v182, v183
    v_exp_f32 v187, v187
    v_mfma_f32_32x32x16_bf16 v[160:175], v[36:39], v[28:31], v[160:175]
    v_exp_f32 v188, v188
    v_cvt_pk_bf16_f32 v180, v184, v185
    v_exp_f32 v189, v189
    v_exp_f32 v190, v190
    v_cvt_pk_bf16_f32 v181, v186, v187
    v_exp_f32 v191, v191
    v_cvt_pk_bf16_f32 v182, v188, v189
    v_cvt_pk_bf16_f32 v183, v190, v191
    s_waitcnt vmcnt(0)
    s_barrier
    s_add_u32 m0, s26, 0
    s_add_u32 s30, s27, 0
    buffer_load_dwordx4 v2, s[8:11], s30 offen lds
    s_add_u32 m0, s26, 1024
    s_add_u32 s30, s27, 1024
    buffer_load_dwordx4 v2, s[8:11], s30 offen lds
    s_add_u32 m0, s26, 2048
    s_add_u32 s30, s27, 2048
    buffer_load_dwordx4 v2, s[8:11], s30 offen lds
    s_cmp_lg_u32 s28, 3
    s_cbranch_scc1 attn_kernel_nowarmf
    s_cmp_lg_u32 s20, 7
    s_cbranch_scc1 attn_kernel_nowarmf
    buffer_load_dword v194, v195, s[52:55], s51 offen
    buffer_load_dword v194, v195, s[56:59], s51 offen
attn_kernel_nowarmf:
    s_cmp_lt_u32 s28, 4
    s_cbranch_scc1 attn_kernel_nostagef
    s_add_u32 s46, s45, 0
    s_min_u32 s46, s46, 64
    s_lshl_b32 s46, s46, 10
    v_lshl_add_u32 v11, v0, 4, s46
    s_mov_b32 s47, 52429
    v_lshrrev_b32 v12, 9, v11
    v_mul_u32_u24 v12, s47, v12
    v_lshrrev_b32 v12, 18, v12
    v_mul_u32_u24 v13, 2560, v12
    v_sub_u32 v13, v11, v13
    v_add_u32 v13, 1280, v13
    v_add_u32 v12, s44, v12
    v_subrev_u32 v12, 14, v12
    v_max_i32 v12, 0, v12
    v_subrev_u32 v14, 56320, v11
    v_lshrrev_b32 v15, 8, v14
    v_mul_u32_u24 v15, s47, v15
    v_lshrrev_b32 v15, 18, v15
    v_mul_u32_u24 v1, 1280, v15
    v_sub_u32 v14, v14, v1
    v_add_u32 v15, s44, v15
    s_mov_b32 s47, 56320
    v_cmp_le_u32 s[48:49], s47, v11
    s_add_u32 m0, s46, 73728
    s_nop 1
    v_cndmask_b32 v12, v12, v15, s[48:49]
    v_cndmask_b32 v13, v13, v14, s[48:49]
    s_mov_b32 s47, 3840
    v_mad_u32_u24 v11, v12, s47, v13
    buffer_load_dwordx4 v11, s[36:39], 0 offen lds
    s_add_u32 s46, s45, 1
    s_min_u32 s46, s46, 64
    s_lshl_b32 s46, s46, 10
    v_lshl_add_u32 v11, v0, 4, s46
    s_mov_b32 s47, 52429
    v_lshrrev_b32 v12, 9, v11
    v_mul_u32_u24 v12, s47, v12
    v_lshrrev_b32 v12, 18, v12
    v_mul_u32_u24 v13, 2560, v12
    v_sub_u32 v13, v11, v13
    v_add_u32 v13, 1280, v13
    v_add_u32 v12, s44, v12
    v_subrev_u32 v12, 14, v12
    v_max_i32 v12, 0, v12
    v_subrev_u32 v14, 56320, v11
    v_lshrrev_b32 v15, 8, v14
    v_mul_u32_u24 v15, s47, v15
    v_lshrrev_b32 v15, 18, v15
    v_mul_u32_u24 v1, 1280, v15
    v_sub_u32 v14, v14, v1
    v_add_u32 v15, s44, v15
    s_mov_b32 s47, 56320
    v_cmp_le_u32 s[48:49], s47, v11
    s_add_u32 m0, s46, 73728
    s_nop 1
    v_cndmask_b32 v12, v12, v15, s[48:49]
    v_cndmask_b32 v13, v13, v14, s[48:49]
    s_mov_b32 s47, 3840
    v_mad_u32_u24 v11, v12, s47, v13
    buffer_load_dwordx4 v11, s[36:39], 0 offen lds
    s_add_u32 s45, s45, 16
attn_kernel_nostagef:
    ds_read_b128 v[48:51], v8 offset:6144
    ds_read_b128 v[52:55], v8 offset:6912
    v_exp_f32 v128, v128
    v_exp_f32 v129, v129
    v_mfma_f32_32x32x16_bf16 v[112:127], v[56:59], v[176:179], v[112:127]
    v_exp_f32 v130, v130
    v_exp_f32 v131, v131
    v_exp_f32 v132, v132
    v_cvt_pk_bf16_f32 v128, v128, v129
    v_mfma_f32_32x32x16_bf16 v[112:127], v[60:63], v[180:183], v[112:127]
    v_exp_f32 v133, v133
    v_exp_f32 v134, v134
    v_cvt_pk_bf16_f32 v129, v130, v131
    v_exp_f32 v135, v135
    s_waitcnt lgkmcnt(2)
    v_mfma_f32_32x32x16_bf16 v[144:159], v[40:43], v[16:19], v[64:79]
    v_exp_f32 v136, v136
    v_cvt_pk_bf16_f32 v130, v132, v133
    v_exp_f32 v137, v137
    v_exp_f32 v138, v138
    v_cvt_pk_bf16_f32 v131, v134, v135
    v_exp_f32 v139, v139
    v_mfma_f32_32x32x16_bf16 v[144:159], v[44:47], v[20:23], v[144:159]
    v_exp_f32 v140, v140
    v_cvt_pk_bf16_f32 v132, v136, v137
    v_exp_f32 v141, v141
    v_exp_f32 v142, v142
    v_cvt_pk_bf16_f32 v133, v138, v139
    v_exp_f32 v143, v143
    v_cvt_pk_bf16_f32 v134, v140, v141
    v_cvt_pk_bf16_f32 v135, v142, v143
    ds_read_b128 v[32:35], v9 offset:0
    ds_read_b128 v[36:39], v10 offset:0
    v_exp_f32 v160, v160
    v_exp_f32 v161, v161
    s_waitcnt lgkmcnt(2)
    v_mfma_f32_32x32x16_bf16 v[96:111], v[48:51], v[128:131], v[96:111]
    v_exp_f32 v162, v162
    v_exp_f32 v163, v163
    v_exp_f32 v164, v164
    v_cvt_pk_bf16_f32 v160, v160, v161
    v_mfma_f32_32x32x16_bf16 v[96:111], v[52:55], v[132:135], v[96:111]
    v_exp_f32 v165, v165
    v_exp_f32 v166, v166
    v_cvt_pk_bf16_f32 v161, v162, v163
    v_exp_f32 v167, v167
    v_mfma_f32_32x32x16_bf16 v[176:191], v[40:43], v[24:27], v[80:95]
    v_exp_f32 v168, v168
    v_cvt_pk_bf16_f32 v162, v164, v165
    v_exp_f32 v169, v169
    v_exp_f32 v170, v170
    v_cvt_pk_bf16_f32 v163, v166, v167
    v_exp_f32 v171, v171
    v_mfma_f32_32x32x16_bf16 v[176:191], v[44:47], v[28:31], v[176:191]
    v_exp_f32 v172, v172
    v_cvt_pk_bf16_f32 v164, v168, v169
    v_exp_f32 v173, v173
    v_exp_f32 v174, v174
    v_cvt_pk_bf16_f32 v165, v170, v171
    v_exp_f32 v175, v175
    v_cvt_pk_bf16_f32 v166, v172, v173
    v_cvt_pk_bf16_f32 v167, v174, v175
    ds_read_b128 v[56:59], v8 offset:9216
    ds_read_b128 v[60:63], v8 offset:9984
    v_exp_f32 v144, v144
    v_exp_f32 v145, v145
    v_mfma_f32_32x32x16_bf16 v[112:127], v[48:51], v[160:163], v[112:127]
    v_exp_f32 v146, v146
    v_exp_f32 v147, v147
    v_exp_f32 v148, v148
    v_cvt_pk_bf16_f32 v144, v144, v145
    v_mfma_f32_32x32x16_bf16 v[112:127], v[52:55], v[164:167], v[112:127]
    v_exp_f32 v149, v149
    v_exp_f32 v150, v150
    v_cvt_pk_bf16_f32 v145, v146, v147
    v_exp_f32 v151, v151
    s_waitcnt lgkmcnt(2)
    v_mfma_f32_32x32x16_bf16 v[128:143], v[32:35], v[16:19], v[64:79]
    v_exp_f32 v152, v152
    v_cvt_pk_bf16_f32 v146, v148, v149
    v_exp_f32 v153, v153
    v_exp_f32 v154, v154
    v_cvt_pk_bf16_f32 v147, v150, v151
    v_exp_f32 v155, v155
    v_mfma_f32_32x32x16_bf16 v[128:143], v[36:39], v[20:23], v[128:143]
    v_exp_f32 v156, v156
    v_cvt_pk_bf16_f32 v148, v152, v153
    v_exp_f32 v157, v157
    v_exp_f32 v158, v158
    v_cvt_pk_bf16_f32 v149, v154, v155
    v_exp_f32 v159, v159
    v_cvt_pk_bf16_f32 v150, v156, v157
    v_cvt_pk_bf16_f32 v151, v158, v159
    ds_read_b128 v[40:43], v9 offset:3072
    ds_read_b128 v[44:47], v10 offset:3072
    v_exp_f32 v176, v176
    v_exp_f32 v177, v177
    s_waitcnt lgkmcnt(2)
    v_mfma_f32_32x32x16_bf16 v[96:111], v[56:59], v[144:147], v[96:111]
    v_exp_f32 v178, v178
    v_exp_f32 v179, v179
    v_exp_f32 v180, v180
    v_cvt_pk_bf16_f32 v176, v176, v177
    v_mfma_f32_32x32x16_bf16 v[96:111], v[60:63], v[148:151], v[96:111]
    v_exp_f32 v181, v181
    v_exp_f32 v182, v182
    v_cvt_pk_bf16_f32 v177, v178, v179
    v_exp_f32 v183, v183
    v_mfma_f32_32x32x16_bf16 v[160:175], v[32:35], v[24:27], v[80:95]
    v_exp_f32 v184, v184
    v_cvt_pk_bf16_f32 v178, v180, v181
    v_exp_f32 v185, v185
    v_exp_f32 v186, v186
    v_cvt_pk_bf16_f32 v179, v182, v183
    v_exp_f32 v187, v187
    v_mfma_f32_32x32x16_bf16 v[160:175], v[36:39], v[28:31], v[160:175]
    v_exp_f32 v188, v188
    v_cvt_pk_bf16_f32 v180, v184, v185
    v_exp_f32 v189, v189
    v_exp_f32 v190, v190
    v_cvt_pk_bf16_f32 v181, v186, v187
    v_exp_f32 v191, v191
    v_cvt_pk_bf16_f32 v182, v188, v189
    v_cvt_pk_bf16_f32 v183, v190, v191
    s_add_u32 s25, s25, 24576
    s_cmp_eq_u32 s25, 73728
    s_cselect_b32 s25, 0, s25
    s_add_u32 s30, s25, 24576
    s_cmp_eq_u32 s30, 73728
    s_cselect_b32 s30, 0, s30
    s_add_u32 s31, s30, 24576
    s_cmp_eq_u32 s31, 73728
    s_cselect_b32 s31, 0, s31
    s_add_u32 s26, s32, s31
    s_add_u32 s27, s27, 12288
    v_add_u32 v6, s25, v3
    v_add_u32 v7, s25, v4
    v_add_u32 v8, s25, v5
    v_add_u32 v9, s30, v3
    v_add_u32 v10, s30, v4
    s_sub_u32 s28, s28, 1
    s_cmp_lg_u32 s28, 0
    s_cbranch_scc1 attn_kernel_loopf
    s_branch attn_kernel_join
attn_kernel_safe:
attn_kernel_loops:
    ds_read_b128 v[48:51], v8 offset:0
    ds_read_b128 v[52:55], v8 offset:768
    s_cbranch_vccnz attn_kernel_rare_0_0
attn_kernel_back_0_0:
    v_exp_f32 v128, v128
    v_exp_f32 v129, v129
    v_mfma_f32_32x32x16_bf16 v[112:127], v[56:59], v[176:179], v[112:127]
    v_exp_f32 v130, v130
    v_max3_f32 v193, v160, v161, v162
    v_exp_f32 v131, v131
    v_max3_f32 v193, v193, v163, v164
    v_exp_f32 v132, v132
    v_cvt_pk_bf16_f32 v128, v128, v129
    v_mfma_f32_32x32x16_bf16 v[112:127], v[60:63], v[180:183], v[112:127]
    v_exp_f32 v133, v133
    v_max3_f32 v193, v193, v165, v166
    v_exp_f32 v134, v134
    v_cvt_pk_bf16_f32 v129, v130, v131
    v_exp_f32 v135, v135
    v_max3_f32 v193, v193, v167, v168
    s_waitcnt lgkmcnt(2)
    v_mfma_f32_32x32x16_bf16 v[144:159], v[40:43], v[16:19], v[64:79]
    v_exp_f32 v136, v136
    v_cvt_pk_bf16_f32 v130, v132, v133
    v_exp_f32 v137, v137
    v_max3_f32 v193, v193, v169, v170
    v_exp_f32 v138, v138
    v_cvt_pk_bf16_f32 v131, v134, v135
    v_exp_f32 v139, v139
    v_max3_f32 v193, v193, v171, v172
    v_mfma_f32_32x32x16_bf16 v[144:159], v[44:47], v[20:23], v[144:159]
    v_exp_f32 v140, v140
    v_cvt_pk_bf16_f32 v132, v136, v137
    v_exp_f32 v141, v141
    v_max3_f32 v193, v193, v173, v174
    v_exp_f32 v142, v142
    v_cvt_pk_bf16_f32 v133, v138, v139
    v_exp_f32 v143, v143
    v_max_f32 v193, v193, v175
    v_cvt_pk_bf16_f32 v134, v140, v141
    v_cmp_lt_f32 vcc, s29, v193
    v_cvt_pk_bf16_f32 v135, v142, v143
    ds_read_b128 v[32:35], v6 offset:6144
    ds_read_b128 v[36:39], v7 offset:6144
    s_cbranch_vccnz attn_kernel_rare_0_1
attn_kernel_back_0_1:
    v_exp_f32 v160, v160
    v_exp_f32 v161, v161
    s_waitcnt lgkmcnt(2)
    v_mfma_f32_32x32x16_bf16 v[96:111], v[48:51], v[128:131], v[96:111]
    v_exp_f32 v162, v162
    v_max3_f32 v192, v144, v145, v146
    v_exp_f32 v163, v163
    v_max3_f32 v192, v192, v147, v148
    v_exp_f32 v164, v164
    v_cvt_pk_bf16_f32 v160, v160, v161
    v_mfma_f32_32x32x16_bf16 v[96:111], v[52:55], v[132:135], v[96:111]
    v_exp_f32 v165, v165
    v_max3_f32 v192, v192, v149, v150
    v_exp_f32 v166, v166
    v_cvt_pk_bf16_f32 v161, v162, v163
    v_exp_f32 v167, v167
    v_max3_f32 v192, v192, v151, v152
    v_mfma_f32_32x32x16_bf16 v[176:191], v[40:43], v[24:27], v[80:95]
    v_exp_f32 v168, v168
    v_cvt_pk_bf16_f32 v162, v164, v165
    v_exp_f32 v169, v169
    v_max3_f32 v192, v192, v153, v154
    v_exp_f32 v170, v170
    v_cvt_pk_bf16_f32 v163, v166, v167
    v_exp_f32 v171, v171
    v_max3_f32 v192, v192, v155, v156
    v_mfma_f32_32x32x16_bf16 v[176:191], v[44:47], v[28:31], v[176:191]
    v_exp_f32 v172, v172
    v_cvt_pk_bf16_f32 v164, v168, v169
    v_exp_f32 v173, v173
    v_max3_f32 v192, v192, v157, v158
    v_exp_f32 v174, v174
    v_cvt_pk_bf16_f32 v165, v170, v171
    v_exp_f32 v175, v175
    v_max_f32 v192, v192, v159
    v_cvt_pk_bf16_f32 v166, v172, v173
    v_cmp_lt_f32 vcc, s29, v192
    v_cvt_pk_bf16_f32 v167, v174, v175
    ds_read_b128 v[56:59], v8 offset:3072
    ds_read_b128 v[60:63], v8 offset:3840
    s_cbranch_vccnz attn_kernel_rare_1_0
attn_kernel_back_1_0:
    v_exp_f32 v144, v144
    v_exp_f32 v145, v145
    v_mfma_f32_32x32x16_bf16 v[112:127], v[48:51], v[160:163], v[112:127]
    v_exp_f32 v146, v146
    v_max3_f32 v193, v176, v177, v178
    v_exp_f32 v147, v147
    v_max3_f32 v193, v193, v179, v180
    v_exp_f32 v148, v148
    v_cvt_pk_bf16_f32 v144, v144, v145
    v_mfma_f32_32x32x16_bf16 v[112:127], v[52:55], v[164:167], v[112:127]
    v_exp_f32 v149, v149
    v_max3_f32 v193, v193, v181, v182
    v_exp_f32 v150, v150
    v_cvt_pk_bf16_f32 v145, v146, v147
    v_exp_f32 v151, v151
    v_max3_f32 v193, v193, v183, v184
    s_waitcnt lgkmcnt(2)
    v_mfma_f32_32x32x16_bf16 v[128:143], v[32:35], v[16:19], v[64:79]
    v_exp_f32 v152, v152
    v_cvt_pk_bf16_f32 v146, v148, v149
    v_exp_f32 v153, v153
    v_max3_f32 v193, v193, v185, v186
    v_exp_f32 v154, v154
    v_cvt_pk_bf16_f32 v147, v150, v151
    v_exp_f32 v155, v155
    v_max3_f32 v193, v193, v187, v188
    v_mfma_f32_32x32x16_bf16 v[128:143], v[36:39], v[20:23], v[128:143]
    v_exp_f32 v156, v156
    v_cvt_pk_bf16_f32 v148, v152, v153
    v_exp_f32 v157, v157
    v_max3_f32 v193, v193, v189, v190
    v_exp_f32 v158, v158
    v_cvt_pk_bf16_f32 v149, v154, v155
    v_exp_f32 v159, v159
    v_max_f32 v193, v193, v191
    v_cvt_pk_bf16_f32 v150, v156, v157
    v_cmp_lt_f32 vcc, s29, v193
    v_cvt_pk_bf16_f32 v151, v158, v159
    ds_read_b128 v[40:43], v6 offset:9216
    ds_read_b128 v[44:47], v7 offset:9216
    s_cbranch_vccnz attn_kernel_rare_1_1
attn_kernel_back_1_1:
    v_exp_f32 v176, v176
    v_exp_f32 v177, v177
    s_waitcnt lgkmcnt(2)
    v_mfma_f32_32x32x16_bf16 v[96:111], v[56:59], v[144:147], v[96:111]
    v_exp_f32 v178, v178
    v_max3_f32 v192, v128, v129, v130
    v_exp_f32 v179, v179
    v_max3_f32 v192, v192, v131, v132
    v_exp_f32 v180, v180
    v_cvt_pk_bf16_f32 v176, v176, v177
    v_mfma_f32_32x32x16_bf16 v[96:111], v[60:63], v[148:151], v[96:111]
    v_exp_f32 v181, v181
    v_max3_f32 v192, v192, v133, v134
    v_exp_f32 v182, v182
    v_cvt_pk_bf16_f32 v177, v178, v179
    v_exp_f32 v183, v183
    v_max3_f32 v192, v192, v135, v136
    v_mfma_f32_32x32x16_bf16 v[160:175], v[32:35], v[24:27], v[80:95]
    v_exp_f32 v184, v184
    v_cvt_pk_bf16_f32 v178, v180, v181
    v_exp_f32 v185, v185
    v_max3_f32 v192, v192, v137, v138
    v_exp_f32 v186, v186
    v_cvt_pk_bf16_f32 v179, v182, v183
    v_exp_f32 v187, v187
    v_max3_f32 v192, v192, v139, v140
    v_mfma_f32_32x32x16_bf16 v[160:175], v[36:39], v[28:31], v[160:175]
    v_exp_f32 v188, v188
    v_cvt_pk_bf16_f32 v180, v184, v185
    v_exp_f32 v189, v189
    v_max3_f32 v192, v192, v141, v142
    v_exp_f32 v190, v190
    v_cvt_pk_bf16_f32 v181, v186, v187
    v_exp_f32 v191, v191
    v_max_f32 v192, v192, v143
    v_cvt_pk_bf16_f32 v182, v188, v189
    v_cmp_lt_f32 vcc, s29, v192
    v_cvt_pk_bf16_f32 v183, v190, v191
    s_waitcnt vmcnt(0)
    s_barrier
    s_add_u32 m0, s26, 0
    s_add_u32 s30, s27, 0
    buffer_load_dwordx4 v2, s[8:11], s30 offen lds
    s_add_u32 m0, s26, 1024
    s_add_u32 s30, s27, 1024
    buffer_load_dwordx4 v2, s[8:11], s30 offen lds
    s_add_u32 m0, s26, 2048
    s_add_u32 s30, s27, 2048
    buffer_load_dwordx4 v2, s[8:11], s30 offen lds
    s_cmp_lg_u32 s28, 3
    s_cbranch_scc1 attn_kernel_nowarms
    s_cmp_lg_u32 s20, 7
    s_cbranch_scc1 attn_kernel_nowarms
    buffer_load_dword v194, v195, s[52:55], s51 offen
    buffer_load_dword v194, v195, s[56:59], s51 offen
attn_kernel_nowarms:
    s_cmp_lt_u32 s28, 4
    s_cbranch_scc1 attn_kernel_nostages
    s_add_u32 s46, s45, 0
    s_min_u32 s46, s46, 64
    s_lshl_b32 s46, s46, 10
    v_lshl_add_u32 v11, v0, 4, s46
    s_mov_b32 s47, 52429
    v_lshrrev_b32 v12, 9, v11
    v_mul_u32_u24 v12, s47, v12
    v_lshrrev_b32 v12, 18, v12
    v_mul_u32_u24 v13, 2560, v12
    v_sub_u32 v13, v11, v13
    v_add_u32 v13, 1280, v13
    v_add_u32 v12, s44, v12
    v_subrev_u32 v12, 14, v12
    v_max_i32 v12, 0, v12
    v_subrev_u32 v14, 56320, v11
    v_lshrrev_b32 v15, 8, v14
    v_mul_u32_u24 v15, s47, v15
    v_lshrrev_b32 v15, 18, v15
    v_mul_u32_u24 v1, 1280, v15
    v_sub_u32 v14, v14, v1
    v_add_u32 v15, s44, v15
    s_mov_b32 s47, 56320
    v_cmp_le_u32 s[48:49], s47, v11
    s_add_u32 m0, s46, 73728
    s_nop 1
    v_cndmask_b32 v12, v12, v15, s[48:49]
    v_cndmask_b32 v13, v13, v14, s[48:49]
    s_mov_b32 s47, 3840
    v_mad_u32_u24 v11, v12, s47, v13
    buffer_load_dwordx4 v11, s[36:39], 0 offen lds
    s_add_u32 s46, s45, 1
    s_min_u32 s46, s46, 64
    s_lshl_b32 s46, s46, 10
    v_lshl_add_u32 v11, v0, 4, s46
    s_mov_b32 s47, 52429
    v_lshrrev_b32 v12, 9, v11
    v_mul_u32_u24 v12, s47, v12
    v_lshrrev_b32 v12, 18, v12
    v_mul_u32_u24 v13, 2560, v12
    v_sub_u32 v13, v11, v13
    v_add_u32 v13, 1280, v13
    v_add_u32 v12, s44, v12
    v_subrev_u32 v12, 14, v12
    v_max_i32 v12, 0, v12
    v_subrev_u32 v14, 56320, v11
    v_lshrrev_b32 v15, 8, v14
    v_mul_u32_u24 v15, s47, v15
    v_lshrrev_b32 v15, 18, v15
    v_mul_u32_u24 v1, 1280, v15
    v_sub_u32 v14, v14, v1
    v_add_u32 v15, s44, v15
    s_mov_b32 s47, 56320
    v_cmp_le_u32 s[48:49], s47, v11
    s_add_u32 m0, s46, 73728
    s_nop 1
    v_cndmask_b32 v12, v12, v15, s[48:49]
    v_cndmask_b32 v13, v13, v14, s[48:49]
    s_mov_b32 s47, 3840
    v_mad_u32_u24 v11, v12, s47, v13
    buffer_load_dwordx4 v11, s[36:39], 0 offen lds
    s_add_u32 s45, s45, 16
attn_kernel_nostages:
    ds_read_b128 v[48:51], v8 offset:6144
    ds_read_b128 v[52:55], v8 offset:6912
    s_cbranch_vccnz attn_kernel_rare_2_0
attn_kernel_back_2_0:
    v_exp_f32 v128, v128
    v_exp_f32 v129, v129
    v_mfma_f32_32x32x16_bf16 v[112:127], v[56:59], v[176:179], v[112:127]
    v_exp_f32 v130, v130
    v_max3_f32 v193, v160, v161, v162
    v_exp_f32 v131, v131
    v_max3_f32 v193, v193, v163, v164
    v_exp_f32 v132, v132
    v_cvt_pk_bf16_f32 v128, v128, v129
    v_mfma_f32_32x32x16_bf16 v[112:127], v[60:63], v[180:183], v[112:127]
    v_exp_f32 v133, v133
    v_max3_f32 v193, v193, v165, v166
    v_exp_f32 v134, v134
    v_cvt_pk_bf16_f32 v129, v130, v131
    v_exp_f32 v135, v135
    v_max3_f32 v193, v193, v167, v168
    s_waitcnt lgkmcnt(2)
    v_mfma_f32_32x32x16_bf16 v[144:159], v[40:43], v[16:19], v[64:79]
    v_exp_f32 v136, v136
    v_cvt_pk_bf16_f32 v130, v132, v133
    v_exp_f32 v137, v137
    v_max3_f32 v193, v193, v169, v170
    v_exp_f32 v138, v138
    v_cvt_pk_bf16_f32 v131, v134, v135
    v_exp_f32 v139, v139
    v_max3_f32 v193, v193, v171, v172
    v_mfma_f32_32x32x16_bf16 v[144:159], v[44:47], v[20:23], v[144:159]
    v_exp_f32 v140, v140
    v_cvt_pk_bf16_f32 v132, v136, v137
    v_exp_f32 v141, v141
    v_max3_f32 v193, v193, v173, v174
    v_exp_f32 v142, v142
    v_cvt_pk_bf16_f32 v133, v138, v139
    v_exp_f32 v143, v143
    v_max_f32 v193, v193, v175
    v_cvt_pk_bf16_f32 v134, v140, v141
    v_cmp_lt_f32 vcc, s29, v193
    v_cvt_pk_bf16_f32 v135, v142, v143
    ds_read_b128 v[32:35], v9 offset:0
    ds_read_b128 v[36:39], v10 offset:0
    s_cbranch_vccnz attn_kernel_rare_2_1
attn_kernel_back_2_1:
    v_exp_f32 v160, v160
    v_exp_f32 v161, v161
    s_waitcnt lgkmcnt(2)
    v_mfma_f32_32x32x16_bf16 v[96:111], v[48:51], v[128:131], v[96:111]
    v_exp_f32 v162, v162
    v_max3_f32 v192, v144, v145, v146
    v_exp_f32 v163, v163
    v_max3_f32 v192, v192, v147, v148
    v_exp_f32 v164, v164
    v_cvt_pk_bf16_f32 v160, v160, v161
    v_mfma_f32_32x32x16_bf16 v[96:111], v[52:55], v[132:135], v[96:111]
    v_exp_f32 v165, v165
    v_max3_f32 v192, v192, v149, v150
    v_exp_f32 v166, v166
    v_cvt_pk_bf16_f32 v161, v162, v163
    v_exp_f32 v167, v167
    v_max3_f32 v192, v192, v151, v152
    v_mfma_f32_32x32x16_bf16 v[176:191], v[40:43], v[24:27], v[80:95]
    v_exp_f32 v168, v168
    v_cvt_pk_bf16_f32 v162, v164, v165
    v_exp_f32 v169, v169
    v_max3_f32 v192, v192, v153, v154
    v_exp_f32 v170, v170
    v_cvt_pk_bf16_f32 v163, v166, v167
    v_exp_f32 v171, v171
    v_max3_f32 v192, v192, v155, v156
    v_mfma_f32_32x32x16_bf16 v[176:191], v[44:47], v[28:31], v[176:191]
    v_exp_f32 v172, v172
    v_cvt_pk_bf16_f32 v164, v168, v169
    v_exp_f32 v173, v173
    v_max3_f32 v192, v192, v157, v158
    v_exp_f32 v174, v174
    v_cvt_pk_bf16_f32 v165, v170, v171
    v_exp_f32 v175, v175
    v_max_f32 v192, v192, v159
    v_cvt_pk_bf16_f32 v166, v172, v173
    v_cmp_lt_f32 vcc, s29, v192
    v_cvt_pk_bf16_f32 v167, v174, v175
    ds_read_b128 v[56:59], v8 offset:9216
    ds_read_b128 v[60:63], v8 offset:9984
    s_cbranch_vccnz attn_kernel_rare_3_0
attn_kernel_back_3_0:
    v_exp_f32 v144, v144
    v_exp_f32 v145, v145
    v_mfma_f32_32x32x16_bf16 v[112:127], v[48:51], v[160:163], v[112:127]
    v_exp_f32 v146, v146
    v_max3_f32 v193, v176, v177, v178
    v_exp_f32 v147, v147
    v_max3_f32 v193, v193, v179, v180
    v_exp_f32 v148, v148
    v_cvt_pk_bf16_f32 v144, v144, v145
    v_mfma_f32_32x32x16_bf16 v[112:127], v[52:55], v[164:167], v[112:127]
    v_exp_f32 v149, v149
    v_max3_f32 v193, v193, v181, v182
    v_exp_f32 v150, v150
    v_cvt_pk_bf16_f32 v145, v146, v147
    v_exp_f32 v151, v151
    v_max3_f32 v193, v193, v183, v184
    s_waitcnt lgkmcnt(2)
    v_mfma_f32_32x32x16_bf16 v[128:143], v[32:35], v[16:19], v[64:79]
    v_exp_f32 v152, v152
    v_cvt_pk_bf16_f32 v146, v148, v149
    v_exp_f32 v153, v153
    v_max3_f32 v193, v193, v185, v186
    v_exp_f32 v154, v154
    v_cvt_pk_bf16_f32 v147, v150, v151
    v_exp_f32 v155, v155
    v_max3_f32 v193, v193, v187, v188
    v_mfma_f32_32x32x16_bf16 v[128:143], v[36:39], v[20:23], v[128:143]
    v_exp_f32 v156, v156
    v_cvt_pk_bf16_f32 v148, v152, v153
    v_exp_f32 v157, v157
    v_max3_f32 v193, v193, v189, v190
    v_exp_f32 v158, v158
    v_cvt_pk_bf16_f32 v149, v154, v155
    v_exp_f32 v159, v159
    v_max_f32 v193, v193, v191
    v_cvt_pk_bf16_f32 v150, v156, v157
    v_cmp_lt_f32 vcc, s29, v193
    v_cvt_pk_bf16_f32 v151, v158, v159
    ds_read_b128 v[40:43], v9 offset:3072
    ds_read_b128 v[44:47], v10 offset:3072
    s_cbranch_vccnz attn_kernel_rare_3_1
attn_kernel_back_3_1:
    v_exp_f32 v176, v176
    v_exp_f32 v177, v177
    s_waitcnt lgkmcnt(2)
    v_mfma_f32_32x32x16_bf16 v[96:111], v[56:59], v[144:147], v[96:111]
    v_exp_f32 v178, v178
    v_max3_f32 v192, v128, v129, v130
    v_exp_f32 v179, v179
    v_max3_f32 v192, v192, v131, v132
    v_exp_f32 v180, v180
    v_cvt_pk_bf16_f32 v176, v176, v177
    v_mfma_f32_32x32x16_bf16 v[96:111], v[60:63], v[148:151], v[96:111]
    v_exp_f32 v181, v181
    v_max3_f32 v192, v192, v133, v134
    v_exp_f32 v182, v182
    v_cvt_pk_bf16_f32 v177, v178, v179
    v_exp_f32 v183, v183
    v_max3_f32 v192, v192, v135, v136
    v_mfma_f32_32x32x16_bf16 v[160:175], v[32:35], v[24:27], v[80:95]
    v_exp_f32 v184, v184
    v_cvt_pk_bf16_f32 v178, v180, v181
    v_exp_f32 v185, v185
    v_max3_f32 v192, v192, v137, v138
    v_exp_f32 v186, v186
    v_cvt_pk_bf16_f32 v179, v182, v183
    v_exp_f32 v187, v187
    v_max3_f32 v192, v192, v139, v140
    v_mfma_f32_32x32x16_bf16 v[160:175], v[36:39], v[28:31], v[160:175]
    v_exp_f32 v188, v188
    v_cvt_pk_bf16_f32 v180, v184, v185
    v_exp_f32 v189, v189
    v_max3_f32 v192, v192, v141, v142
    v_exp_f32 v190, v190
    v_cvt_pk_bf16_f32 v181, v186, v187
    v_exp_f32 v191, v191
    v_max_f32 v192, v192, v143
    v_cvt_pk_bf16_f32 v182, v188, v189
    v_cmp_lt_f32 vcc, s29, v192
    v_cvt_pk_bf16_f32 v183, v190, v191
    s_add_u32 s25, s25, 24576
    s_cmp_eq_u32 s25, 73728
    s_cselect_b32 s25, 0, s25
    s_add_u32 s30, s25, 24576
    s_cmp_eq_u32 s30, 73728
    s_cselect_b32 s30, 0, s30
    s_add_u32 s31, s30, 24576
    s_cmp_eq_u32 s31, 73728
    s_cselect_b32 s31, 0, s31
    s_add_u32 s26, s32, s31
    s_add_u32 s27, s27, 12288
    v_add_u32 v6, s25, v3
    v_add_u32 v7, s25, v4
    v_add_u32 v8, s25, v5
    v_add_u32 v9, s30, v3
    v_add_u32 v10, s30, v4
    s_sub_u32 s28, s28, 1
    s_cmp_lg_u32 s28, 0
    s_cbranch_scc1 attn_kernel_loops
attn_kernel_join:
    v_mfma_f32_32x32x16_bf16 v[112:127], v[56:59], v[176:179], v[112:127]
    v_mfma_f32_32x32x16_bf16 v[112:127], v[60:63], v[180:183], v[112:127]
    s_waitcnt vmcnt(0) lgkmcnt(0)
    s_nop 15
    s_nop 15
    s_mov_b32 s46, 0x71800000
    v_mov_b32 v11, 0
    v_max3_f32 v11, |v96|, |v97|, v11
    v_max3_f32 v11, |v98|, |v99|, v11
    v_max3_f32 v11, |v100|, |v101|, v11
    v_max3_f32 v11, |v102|, |v103|, v11
    v_cmp_nlt_f32 vcc, |v104|, s46
    s_mov_b64 s[84:85], vcc
    v_max3_f32 v11, |v112|, |v113|, v11
    v_max3_f32 v11, |v114|, |v115|, v11
    v_max3_f32 v11, |v116|, |v117|, v11
    v_max3_f32 v11, |v118|, |v119|, v11
    v_cmp_nlt_f32 vcc, |v120|, s46
    s_mov_b64 s[86:87], vcc
    v_cmp_nlt_f32 vcc, v11, s46
    v_cmp_u_f32 s[88:89], v96, v112
    s_or_b64 vcc, vcc, s[84:85]
    s_or_b64 vcc, vcc, s[86:87]
    s_or_b64 vcc, vcc, s[88:89]
    s_cselect_b32 s46, 1, 0
    s_lshl_b32 s47, s20, 2
    s_add_u32 s47, s47, 140288
    v_mov_b32 v12, s47
    v_mov_b32 v13, s46
    ds_write_b32 v12, v13
    s_waitcnt lgkmcnt(0)
    s_barrier
    s_cmp_lg_u32 s50, 0
    s_cbranch_scc1 attn_kernel_novote
    v_and_b32 v12, 7, v0
    v_lshlrev_b32 v12, 2, v12
    v_add_u32 v12, 140288, v12
    ds_read_b32 v13, v12
    s_waitcnt lgkmcnt(0)
    v_cmp_ne_u32 vcc, 0, v13
    s_cbranch_vccz attn_kernel_novote
    s_mov_b32 s50, 1
    s_barrier
    s_branch attn_kernel_restart
attn_kernel_novote:
    s_mul_i32 s30, s21, 6656
    v_lshlrev_b32 v13, 2, v0
    v_add_u32 v13, s30, v13
    s_cmp_eq_u32 s22, 0
    s_cbranch_scc1 attn_kernel_comb0
    ds_write_b32 v13, v96 offset:0
    ds_write_b32 v13, v97 offset:256
    ds_write_b32 v13, v98 offset:512
    ds_write_b32 v13, v99 offset:768
    ds_write_b32 v13, v100 offset:1024
    ds_write_b32 v13, v101 offset:1280
    ds_write_b32 v13, v102 offset:1536
    ds_write_b32 v13, v103 offset:1792
    ds_write_b32 v13, v104 offset:2048
    ds_write_b32 v13, v105 offset:2304
    ds_write_b32 v13, v106 offset:2560
    ds_write_b32 v13, v107 offset:2816
    ds_write_b32 v13, v64 offset:3072
    ds_write_b32 v13, v112 offset:3328
    ds_write_b32 v13, v113 offset:3584
    ds_write_b32 v13, v114 offset:3840
    ds_write_b32 v13, v115 offset:4096
    ds_write_b32 v13, v116 offset:4352
    ds_write_b32 v13, v117 offset:4608
    ds_write_b32 v13, v118 offset:4864
    ds_write_b32 v13, v119 offset:5120
    ds_write_b32 v13, v120 offset:5376
    ds_write_b32 v13, v121 offset:5632
    ds_write_b32 v13, v122 offset:5888
    ds_write_b32 v13, v123 offset:6144
    ds_write_b32 v13, v80 offset:6400
    s_waitcnt lgkmcnt(0)
    s_barrier
    s_branch attn_kernel_local
attn_kernel_comb0:
    s_barrier
    ds_read_b32 v128, v13 offset:0
    ds_read_b32 v129, v13 offset:256
    ds_read_b32 v130, v13 offset:512
    ds_read_b32 v131, v13 offset:768
    ds_read_b32 v132, v13 offset:1024
    ds_read_b32 v133, v13 offset:1280
    ds_read_b32 v134, v13 offset:1536
    ds_read_b32 v135, v13 offset:1792
    ds_read_b32 v136, v13 offset:2048
    ds_read_b32 v137, v13 offset:2304
    ds_read_b32 v138, v13 offset:2560
    ds_read_b32 v139, v13 offset:2816
    ds_read_b32 v140, v13 offset:3072
    ds_read_b32 v144, v13 offset:3328
    ds_read_b32 v145, v13 offset:3584
    ds_read_b32 v146, v13 offset:3840
    ds_read_b32 v147, v13 offset:4096
    ds_read_b32 v148, v13 offset:4352
    ds_read_b32 v149, v13 offset:4608
    ds_read_b32 v150, v13 offset:4864
    ds_read_b32 v151, v13 offset:5120
    ds_read_b32 v152, v13 offset:5376
    ds_read_b32 v153, v13 offset:5632
    ds_read_b32 v154, v13 offset:5888
    ds_read_b32 v155, v13 offset:6144
    ds_read_b32 v156, v13 offset:6400
    v_and_b32 v11, 31, v0
    v_lshrrev_b32 v12, 5, v0
    s_lshl_b32 s30, s24, 8
    s_lshl_b32 s31, s21, 6
    s_add_u32 s30, s30, s31
    v_add_u32 v11, s30, v11
    s_mov_b32 s31, 1280
    s_mul_i32 s30, s23, 40
    v_lshlrev_b32 v12, 3, v12
    v_add_u32 v12, s30, v12
    v_mad_u32_u24 v14, v11, s31, v12
    v_add_u32 v15, 40960, v14
    s_waitcnt lgkmcnt(0)
    v_min_f32 v11, v64, v140
    v_sub_f32 v12, v11, v64
    v_sub_f32 v13, v11, v140
    v_exp_f32 v12, v12
    v_exp_f32 v13, v13
    s_nop 0
    v_mul_f32 v96, v96, v12
    v_fmac_f32 v96, v128, v13
    v_mul_f32 v97, v97, v12
    v_fmac_f32 v97, v129, v13
    v_mul_f32 v98, v98, v12
    v_fmac_f32 v98, v130, v13
    v_mul_f32 v99, v99, v12
    v_fmac_f32 v99, v131, v13
    v_mul_f32 v100, v100, v12
    v_fmac_f32 v100, v132, v13
    v_mul_f32 v101, v101, v12
    v_fmac_f32 v101, v133, v13
    v_mul_f32 v102, v102, v12
    v_fmac_f32 v102, v134, v13
    v_mul_f32 v103, v103, v12
    v_fmac_f32 v103, v135, v13
    v_mul_f32 v104, v104, v12
    v_fmac_f32 v104, v136, v13
    v_mul_f32 v105, v105, v12
    v_fmac_f32 v105, v137, v13
    v_mul_f32 v106, v106, v12
    v_fmac_f32 v106, v138, v13
    v_mul_f32 v107, v107, v12
    v_fmac_f32 v107, v139, v13
    v_mov_b32 v11, v104
    v_mov_b32 v12, v104
    s_nop 1
    v_permlane32_swap_b32 v11, v12
    v_rcp_f32 v12, v12
    s_nop 0
    v_mul_f32 v96, v96, v12
    v_mul_f32 v97, v97, v12
    v_mul_f32 v98, v98, v12
    v_mul_f32 v99, v99, v12
    v_mul_f32 v100, v100, v12
    v_mul_f32 v101, v101, v12
    v_mul_f32 v102, v102, v12
    v_mul_f32 v103, v103, v12
    v_mul_f32 v104, v104, v12
    v_mul_f32 v105, v105, v12
    v_mul_f32 v106, v106, v12
    v_mul_f32 v107, v107, v12
    v_cvt_pk_bf16_f32 v96, v96, v97
    v_cvt_pk_bf16_f32 v97, v98, v99
    v_cvt_pk_bf16_f32 v100, v100, v101
    v_cvt_pk_bf16_f32 v101, v102, v103
    v_cvt_pk_bf16_f32 v104, v104, v105
    v_cvt_pk_bf16_f32 v105, v106, v107
    buffer_store_dwordx2 v[96:97], v14, s[16:19], 0 offen offset:0
    buffer_store_dwordx2 v[100:101], v14, s[16:19], 0 offen offset:16
    v_min_f32 v11, v80, v156
    v_sub_f32 v12, v11, v80
    v_sub_f32 v13, v11, v156
    v_exp_f32 v12, v12
    v_exp_f32 v13, v13
    s_nop 0
    v_mul_f32 v112, v112, v12
    v_fmac_f32 v112, v144, v13
    v_mul_f32 v113, v113, v12
    v_fmac_f32 v113, v145, v13
    v_mul_f32 v114, v114, v12
    v_fmac_f32 v114, v146, v13
    v_mul_f32 v115, v115, v12
    v_fmac_f32 v115, v147, v13
    v_mul_f32 v116, v116, v12
    v_fmac_f32 v116, v148, v13
    v_mul_f32 v117, v117, v12
    v_fmac_f32 v117, v149, v13
    v_mul_f32 v118, v118, v12
    v_fmac_f32 v118, v150, v13
    v_mul_f32 v119, v119, v12
    v_fmac_f32 v119, v151, v13
    v_mul_f32 v120, v120, v12
    v_fmac_f32 v120, v152, v13
    v_mul_f32 v121, v121, v12
    v_fmac_f32 v121, v153, v13
    v_mul_f32 v122, v122, v12
    v_fmac_f32 v122, v154, v13
    v_mul_f32 v123, v123, v12
    v_fmac_f32 v123, v155, v13
    v_mov_b32 v11, v120
    v_mov_b32 v12, v120
    s_nop 1
    v_permlane32_swap_b32 v11, v12
    v_rcp_f32 v12, v12
    s_nop 0
    v_mul_f32 v112, v112, v12
    v_mul_f32 v113, v113, v12
    v_mul_f32 v114, v114, v12
    v_mul_f32 v115, v115, v12
    v_mul_f32 v116, v116, v12
    v_mul_f32 v117, v117, v12
    v_mul_f32 v118, v118, v12
    v_mul_f32 v119, v119, v12
    v_mul_f32 v120, v120, v12
    v_mul_f32 v121, v121, v12
    v_mul_f32 v122, v122, v12
    v_mul_f32 v123, v123, v12
    v_cvt_pk_bf16_f32 v112, v112, v113
    v_cvt_pk_bf16_f32 v113, v114, v115
    v_cvt_pk_bf16_f32 v116, v116, v117
    v_cvt_pk_bf16_f32 v117, v118, v119
    v_cvt_pk_bf16_f32 v120, v120, v121
    v_cvt_pk_bf16_f32 v121, v122, v123
    buffer_store_dwordx2 v[112:113], v15, s[16:19], 0 offen offset:0
    buffer_store_dwordx2 v[116:117], v15, s[16:19], 0 offen offset:16
    v_cmp_gt_u32 vcc, 32, v0
    s_and_saveexec_b64 s[34:35], vcc
    s_cbranch_execz attn_kernel_st_skip
    buffer_store_dwordx2 v[104:105], v14, s[16:19], 0 offen offset:32
    buffer_store_dwordx2 v[120:121], v15, s[16:19], 0 offen offset:32
attn_kernel_st_skip:
    s_mov_b64 exec, s[34:35]
    s_nop 1
attn_kernel_local:
    v_lshrrev_b32 v28, 1, v0
    v_mul_u32_u24 v28, 40, v28
    v_and_b32 v30, 1, v0
    v_mad_u32_u24 v30, v30, 24, v28
    s_add_u32 s46, s44, s20
    s_mul_i32 s47, s20, 1280
    s_add_u32 s47, s47, 130048
    v_add_u32 v29, s47, v30
    ds_read_b64 v[64:65], v29 offset:0
    ds_read_b64 v[66:67], v29 offset:8
    ds_read_b64 v[68:69], v29 offset:16
    s_mul_i32 s47, s20, 2560
    s_add_u32 s47, s47, 73728
    v_add_u32 v29, s47, v30
    ds_read_b64 v[70:71], v29 offset:35840
    ds_read_b64 v[72:73], v29 offset:35848
    ds_read_b64 v[74:75], v29 offset:35856
    ds_read_b64 v[76:77], v29 offset:30720
    ds_read_b64 v[78:79], v29 offset:30728
    ds_read_b64 v[80:81], v29 offset:30736
    ds_read_b64 v[82:83], v29 offset:25600
    ds_read_b64 v[84:85], v29 offset:25608
    ds_read_b64 v[86:87], v29 offset:25616
    ds_read_b64 v[88:89], v29 offset:20480
    ds_read_b64 v[90:91], v29 offset:20488
    ds_read_b64 v[92:93], v29 offset:20496
    s_waitcnt lgkmcnt(3)
    ds_read_b64 v[94:95], v29 offset:15360
    ds_read_b64 v[96:97], v29 offset:15368
    ds_read_b64 v[98:99], v29 offset:15376
    ds_read_b64 v[100:101], v29 offset:10240
    ds_read_b64 v[102:103], v29 offset:10248
    ds_read_b64 v[104:105], v29 offset:10256
    ds_read_b64 v[106:107], v29 offset:5120
    ds_read_b64 v[108:109], v29 offset:5128
    ds_read_b64 v[110:111], v29 offset:5136
    ds_read_b64 v[112:113], v29 offset:0
    ds_read_b64 v[114:115], v29 offset:8
    ds_read_b64 v[116:117], v29 offset:16
    s_waitcnt lgkmcnt(3)
    v_mov_b32 v32, 0
    v_mov_b32 v33, 0
    v_mov_b32 v34, 0
    v_mov_b32 v35, 0
    v_mov_b32 v36, 0
    v_mov_b32 v37, 0
    v_mov_b32 v38, 0
    v_mov_b32 v39, 0
    v_mov_b32 v48, 0
    v_mov_b32 v49, 0
    v_mov_b32 v50, 0
    v_mov_b32 v51, 0
    v_mov_b32 v52, 0
    v_mov_b32 v53, 0
    v_mov_b32 v54, 0
    v_mov_b32 v55, 0
    v_mov_b32 v56, 0
    v_mov_b32 v57, 0
    v_mov_b32 v58, 0
    v_mov_b32 v59, 0
    v_and_b32 v60, 1, v0
    v_cmp_eq_u32 vcc, 0, v60
    s_waitcnt lgkmcnt(0)
    v_cndmask_b32 v68, 0, v68, vcc
    v_cndmask_b32 v69, 0, v69, vcc
    ds_read_b64 v[118:119], v29 offset:37120
    ds_read_b64 v[120:121], v29 offset:37128
    ds_read_b64 v[122:123], v29 offset:37136
    ds_read_b64 v[124:125], v29 offset:32000
    ds_read_b64 v[126:127], v29 offset:32008
    ds_read_b64 v[128:129], v29 offset:32016
    ds_read_b64 v[130:131], v29 offset:26880
    ds_read_b64 v[132:133], v29 offset:26888
    ds_read_b64 v[134:135], v29 offset:26896
    ds_read_b64 v[136:137], v29 offset:21760
    ds_read_b64 v[138:139], v29 offset:21768
    ds_read_b64 v[140:141], v29 offset:21776
    s_waitcnt lgkmcnt(3)
    ds_read_b64 v[142:143], v29 offset:16640
    ds_read_b64 v[144:145], v29 offset:16648
    ds_read_b64 v[146:147], v29 offset:16656
    ds_read_b64 v[148:149], v29 offset:11520
    ds_read_b64 v[150:151], v29 offset:11528
    ds_read_b64 v[152:153], v29 offset:11536
    ds_read_b64 v[154:155], v29 offset:6400
    ds_read_b64 v[156:157], v29 offset:6408
    ds_read_b64 v[158:159], v29 offset:6416
    ds_read_b64 v[160:161], v29 offset:1280
    ds_read_b64 v[162:163], v29 offset:1288
    ds_read_b64 v[164:165], v29 offset:1296
    s_waitcnt lgkmcnt(3)
    v_dot2_f32_bf16 v32, v64, v70, v32
    v_dot2_f32_bf16 v33, v64, v76, v33
    v_dot2_f32_bf16 v34, v64, v82, v34
    v_dot2_f32_bf16 v35, v64, v88, v35
    v_dot2_f32_bf16 v36, v64, v94, v36
    v_dot2_f32_bf16 v37, v64, v100, v37
    v_dot2_f32_bf16 v38, v64, v106, v38
    v_dot2_f32_bf16 v39, v64, v112, v39
    v_dot2_f32_bf16 v32, v65, v71, v32
    v_dot2_f32_bf16 v33, v65, v77, v33
    v_dot2_f32_bf16 v34, v65, v83, v34
    v_dot2_f32_bf16 v35, v65, v89, v35
    v_dot2_f32_bf16 v36, v65, v95, v36
    v_dot2_f32_bf16 v37, v65, v101, v37
    v_dot2_f32_bf16 v38, v65, v107, v38
    v_dot2_f32_bf16 v39, v65, v113, v39
    v_dot2_f32_bf16 v32, v66, v72, v32
    v_dot2_f32_bf16 v33, v66, v78, v33
    v_dot2_f32_bf16 v34, v66, v84, v34
    v_dot2_f32_bf16 v35, v66, v90, v35
    v_dot2_f32_bf16 v36, v66, v96, v36
    v_dot2_f32_bf16 v37, v66, v102, v37
    v_dot2_f32_bf16 v38, v66, v108, v38
    v_dot2_f32_bf16 v39, v66, v114, v39
    v_dot2_f32_bf16 v32, v67, v73, v32
    v_dot2_f32_bf16 v33, v67, v79, v33
    v_dot2_f32_bf16 v34, v67, v85, v34
    v_dot2_f32_bf16 v35, v67, v91, v35
    v_dot2_f32_bf16 v36, v67, v97, v36
    v_dot2_f32_bf16 v37, v67, v103, v37
    v_dot2_f32_bf16 v38, v67, v109, v38
    v_dot2_f32_bf16 v39, v67, v115, v39
    v_dot2_f32_bf16 v32, v68, v74, v32
    v_dot2_f32_bf16 v33, v68, v80, v33
    v_dot2_f32_bf16 v34, v68, v86, v34
    v_dot2_f32_bf16 v35, v68, v92, v35
    v_dot2_f32_bf16 v36, v68, v98, v36
    v_dot2_f32_bf16 v37, v68, v104, v37
    v_dot2_f32_bf16 v38, v68, v110, v38
    v_dot2_f32_bf16 v39, v68, v116, v39
    v_dot2_f32_bf16 v32, v69, v75, v32
    v_dot2_f32_bf16 v33, v69, v81, v33
    v_dot2_f32_bf16 v34, v69, v87, v34
    v_dot2_f32_bf16 v35, v69, v93, v35
    v_dot2_f32_bf16 v36, v69, v99, v36
    v_dot2_f32_bf16 v37, v69, v105, v37
    v_dot2_f32_bf16 v38, v69, v111, v38
    v_dot2_f32_bf16 v39, v69, v117, v39
    s_nop 3
    v_add_f32_dpp v40, v32, v32 quad_perm:[1,0,3,2] row_mask:0xf bank_mask:0xf
    v_add_f32_dpp v41, v33, v33 quad_perm:[1,0,3,2] row_mask:0xf bank_mask:0xf
    v_add_f32_dpp v42, v34, v34 quad_perm:[1,0,3,2] row_mask:0xf bank_mask:0xf
    v_add_f32_dpp v43, v35, v35 quad_perm:[1,0,3,2] row_mask:0xf bank_mask:0xf
    v_add_f32_dpp v44, v36, v36 quad_perm:[1,0,3,2] row_mask:0xf bank_mask:0xf
    v_add_f32_dpp v45, v37, v37 quad_perm:[1,0,3,2] row_mask:0xf bank_mask:0xf
    v_add_f32_dpp v46, v38, v38 quad_perm:[1,0,3,2] row_mask:0xf bank_mask:0xf
    v_add_f32_dpp v47, v39, v39 quad_perm:[1,0,3,2] row_mask:0xf bank_mask:0xf
    s_mov_b32 s47, 0x3ea52b5c
    v_mov_b32 v29, 0xf149f2ca
    v_mul_f32 v32, s47, v40
    v_mul_f32 v33, s47, v41
    v_mul_f32 v34, s47, v42
    v_mul_f32 v35, s47, v43
    v_mul_f32 v36, s47, v44
    v_mul_f32 v37, s47, v45
    v_mul_f32 v38, s47, v46
    v_mul_f32 v39, s47, v47
    s_cmp_ge_u32 s46, 2
    s_cbranch_scc1 attn_kernel_lv_1
    v_mov_b32 v33, v29
attn_kernel_lv_1:
    s_cmp_ge_u32 s46, 4
    s_cbranch_scc1 attn_kernel_lv_2
    v_mov_b32 v34, v29
attn_kernel_lv_2:
    s_cmp_ge_u32 s46, 6
    s_cbranch_scc1 attn_kernel_lv_3
    v_mov_b32 v35, v29
attn_kernel_lv_3:
    s_cmp_ge_u32 s46, 8
    s_cbranch_scc1 attn_kernel_lv_4
    v_mov_b32 v36, v29
attn_kernel_lv_4:
    s_cmp_ge_u32 s46, 10
    s_cbranch_scc1 attn_kernel_lv_5
    v_mov_b32 v37, v29
attn_kernel_lv_5:
    s_cmp_ge_u32 s46, 12
    s_cbranch_scc1 attn_kernel_lv_6
    v_mov_b32 v38, v29
attn_kernel_lv_6:
    s_cmp_ge_u32 s46, 14
    s_cbranch_scc1 attn_kernel_lv_7
    v_mov_b32 v39, v29
attn_kernel_lv_7:
    v_max3_f32 v60, v32, v33, v34
    v_max3_f32 v60, v60, v35, v36
    v_max3_f32 v60, v60, v37, v38
    v_max_f32 v60, v60, v39
    v_sub_f32 v32, v32, v60
    v_sub_f32 v33, v33, v60
    v_sub_f32 v34, v34, v60
    v_sub_f32 v35, v35, v60
    v_sub_f32 v36, v36, v60
    v_sub_f32 v37, v37, v60
    v_sub_f32 v38, v38, v60
    v_sub_f32 v39, v39, v60
    v_exp_f32 v32, v32
    v_exp_f32 v33, v33
    v_exp_f32 v34, v34
    v_exp_f32 v35, v35
    v_exp_f32 v36, v36
    v_exp_f32 v37, v37
    v_exp_f32 v38, v38
    v_exp_f32 v39, v39
    s_nop 0
    v_add_f32 v61, v32, v33
    v_add_f32 v61, v61, v34
    v_add_f32 v61, v61, v35
    v_add_f32 v61, v61, v36
    v_add_f32 v61, v61, v37
    v_add_f32 v61, v61, v38
    v_add_f32 v61, v61, v39
    v_rcp_f32 v61, v61
    s_nop 0
    v_mul_f32 v32, v32, v61
    v_mul_f32 v33, v33, v61
    v_mul_f32 v34, v34, v61
    v_mul_f32 v35, v35, v61
    v_mul_f32 v36, v36, v61
    v_mul_f32 v37, v37, v61
    v_mul_f32 v38, v38, v61
    v_mul_f32 v39, v39, v61
    s_waitcnt lgkmcnt(0)
    v_lshlrev_b32 v62, 16, v118
    v_and_b32 v63, 0xffff0000, v118
    v_fmac_f32 v48, v32, v62
    v_fmac_f32 v49, v32, v63
    v_lshlrev_b32 v62, 16, v119
    v_and_b32 v63, 0xffff0000, v119
    v_fmac_f32 v50, v32, v62
    v_fmac_f32 v51, v32, v63
    v_lshlrev_b32 v62, 16, v120
    v_and_b32 v63, 0xffff0000, v120
    v_fmac_f32 v52, v32, v62
    v_fmac_f32 v53, v32, v63
    v_lshlrev_b32 v62, 16, v121
    v_and_b32 v63, 0xffff0000, v121
    v_fmac_f32 v54, v32, v62
    v_fmac_f32 v55, v32, v63
    v_lshlrev_b32 v62, 16, v122
    v_and_b32 v63, 0xffff0000, v122
    v_fmac_f32 v56, v32, v62
    v_fmac_f32 v57, v32, v63
    v_lshlrev_b32 v62, 16, v123
    v_and_b32 v63, 0xffff0000, v123
    v_fmac_f32 v58, v32, v62
    v_fmac_f32 v59, v32, v63
    v_lshlrev_b32 v62, 16, v124
    v_and_b32 v63, 0xffff0000, v124
    v_fmac_f32 v48, v33, v62
    v_fmac_f32 v49, v33, v63
    v_lshlrev_b32 v62, 16, v125
    v_and_b32 v63, 0xffff0000, v125
    v_fmac_f32 v50, v33, v62
    v_fmac_f32 v51, v33, v63
    v_lshlrev_b32 v62, 16, v126
    v_and_b32 v63, 0xffff0000, v126
    v_fmac_f32 v52, v33, v62
    v_fmac_f32 v53, v33, v63
    v_lshlrev_b32 v62, 16, v127
    v_and_b32 v63, 0xffff0000, v127
    v_fmac_f32 v54, v33, v62
    v_fmac_f32 v55, v33, v63
    v_lshlrev_b32 v62, 16, v128
    v_and_b32 v63, 0xffff0000, v128
    v_fmac_f32 v56, v33, v62
    v_fmac_f32 v57, v33, v63
    v_lshlrev_b32 v62, 16, v129
    v_and_b32 v63, 0xffff0000, v129
    v_fmac_f32 v58, v33, v62
    v_fmac_f32 v59, v33, v63
    v_lshlrev_b32 v62, 16, v130
    v_and_b32 v63, 0xffff0000, v130
    v_fmac_f32 v48, v34, v62
    v_fmac_f32 v49, v34, v63
    v_lshlrev_b32 v62, 16, v131
    v_and_b32 v63, 0xffff0000, v131
    v_fmac_f32 v50, v34, v62
    v_fmac_f32 v51, v34, v63
    v_lshlrev_b32 v62, 16, v132
    v_and_b32 v63, 0xffff0000, v132
    v_fmac_f32 v52, v34, v62
    v_fmac_f32 v53, v34, v63
    v_lshlrev_b32 v62, 16, v133
    v_and_b32 v63, 0xffff0000, v133
    v_fmac_f32 v54, v34, v62
    v_fmac_f32 v55, v34, v63
    v_lshlrev_b32 v62, 16, v134
    v_and_b32 v63, 0xffff0000, v134
    v_fmac_f32 v56, v34, v62
    v_fmac_f32 v57, v34, v63
    v_lshlrev_b32 v62, 16, v135
    v_and_b32 v63, 0xffff0000, v135
    v_fmac_f32 v58, v34, v62
    v_fmac_f32 v59, v34, v63
    v_lshlrev_b32 v62, 16, v136
    v_and_b32 v63, 0xffff0000, v136
    v_fmac_f32 v48, v35, v62
    v_fmac_f32 v49, v35, v63
    v_lshlrev_b32 v62, 16, v137
    v_and_b32 v63, 0xffff0000, v137
    v_fmac_f32 v50, v35, v62
    v_fmac_f32 v51, v35, v63
    v_lshlrev_b32 v62, 16, v138
    v_and_b32 v63, 0xffff0000, v138
    v_fmac_f32 v52, v35, v62
    v_fmac_f32 v53, v35, v63
    v_lshlrev_b32 v62, 16, v139
    v_and_b32 v63, 0xffff0000, v139
    v_fmac_f32 v54, v35, v62
    v_fmac_f32 v55, v35, v63
    v_lshlrev_b32 v62, 16, v140
    v_and_b32 v63, 0xffff0000, v140
    v_fmac_f32 v56, v35, v62
    v_fmac_f32 v57, v35, v63
    v_lshlrev_b32 v62, 16, v141
    v_and_b32 v63, 0xffff0000, v141
    v_fmac_f32 v58, v35, v62
    v_fmac_f32 v59, v35, v63
    v_lshlrev_b32 v62, 16, v142
    v_and_b32 v63, 0xffff0000, v142
    v_fmac_f32 v48, v36, v62
    v_fmac_f32 v49, v36, v63
    v_lshlrev_b32 v62, 16, v143
    v_and_b32 v63, 0xffff0000, v143
    v_fmac_f32 v50, v36, v62
    v_fmac_f32 v51, v36, v63
    v_lshlrev_b32 v62, 16, v144
    v_and_b32 v63, 0xffff0000, v144
    v_fmac_f32 v52, v36, v62
    v_fmac_f32 v53, v36, v63
    v_lshlrev_b32 v62, 16, v145
    v_and_b32 v63, 0xffff0000, v145
    v_fmac_f32 v54, v36, v62
    v_fmac_f32 v55, v36, v63
    v_lshlrev_b32 v62, 16, v146
    v_and_b32 v63, 0xffff0000, v146
    v_fmac_f32 v56, v36, v62
    v_fmac_f32 v57, v36, v63
    v_lshlrev_b32 v62, 16, v147
    v_and_b32 v63, 0xffff0000, v147
    v_fmac_f32 v58, v36, v62
    v_fmac_f32 v59, v36, v63
    v_lshlrev_b32 v62, 16, v148
    v_and_b32 v63, 0xffff0000, v148
    v_fmac_f32 v48, v37, v62
    v_fmac_f32 v49, v37, v63
    v_lshlrev_b32 v62, 16, v149
    v_and_b32 v63, 0xffff0000, v149
    v_fmac_f32 v50, v37, v62
    v_fmac_f32 v51, v37, v63
    v_lshlrev_b32 v62, 16, v150
    v_and_b32 v63, 0xffff0000, v150
    v_fmac_f32 v52, v37, v62
    v_fmac_f32 v53, v37, v63
    v_lshlrev_b32 v62, 16, v151
    v_and_b32 v63, 0xffff0000, v151
    v_fmac_f32 v54, v37, v62
    v_fmac_f32 v55, v37, v63
    v_lshlrev_b32 v62, 16, v152
    v_and_b32 v63, 0xffff0000, v152
    v_fmac_f32 v56, v37, v62
    v_fmac_f32 v57, v37, v63
    v_lshlrev_b32 v62, 16, v153
    v_and_b32 v63, 0xffff0000, v153
    v_fmac_f32 v58, v37, v62
    v_fmac_f32 v59, v37, v63
    v_lshlrev_b32 v62, 16, v154
    v_and_b32 v63, 0xffff0000, v154
    v_fmac_f32 v48, v38, v62
    v_fmac_f32 v49, v38, v63
    v_lshlrev_b32 v62, 16, v155
    v_and_b32 v63, 0xffff0000, v155
    v_fmac_f32 v50, v38, v62
    v_fmac_f32 v51, v38, v63
    v_lshlrev_b32 v62, 16, v156
    v_and_b32 v63, 0xffff0000, v156
    v_fmac_f32 v52, v38, v62
    v_fmac_f32 v53, v38, v63
    v_lshlrev_b32 v62, 16, v157
    v_and_b32 v63, 0xffff0000, v157
    v_fmac_f32 v54, v38, v62
    v_fmac_f32 v55, v38, v63
    v_lshlrev_b32 v62, 16, v158
    v_and_b32 v63, 0xffff0000, v158
    v_fmac_f32 v56, v38, v62
    v_fmac_f32 v57, v38, v63
    v_lshlrev_b32 v62, 16, v159
    v_and_b32 v63, 0xffff0000, v159
    v_fmac_f32 v58, v38, v62
    v_fmac_f32 v59, v38, v63
    v_lshlrev_b32 v62, 16, v160
    v_and_b32 v63, 0xffff0000, v160
    v_fmac_f32 v48, v39, v62
    v_fmac_f32 v49, v39, v63
    v_lshlrev_b32 v62, 16, v161
    v_and_b32 v63, 0xffff0000, v161
    v_fmac_f32 v50, v39, v62
    v_fmac_f32 v51, v39, v63
    v_lshlrev_b32 v62, 16, v162
    v_and_b32 v63, 0xffff0000, v162
    v_fmac_f32 v52, v39, v62
    v_fmac_f32 v53, v39, v63
    v_lshlrev_b32 v62, 16, v163
    v_and_b32 v63, 0xffff0000, v163
    v_fmac_f32 v54, v39, v62
    v_fmac_f32 v55, v39, v63
    v_lshlrev_b32 v62, 16, v164
    v_and_b32 v63, 0xffff0000, v164
    v_fmac_f32 v56, v39, v62
    v_fmac_f32 v57, v39, v63
    v_lshlrev_b32 v62, 16, v165
    v_and_b32 v63, 0xffff0000, v165
    v_fmac_f32 v58, v39, v62
    v_fmac_f32 v59, v39, v63
    v_cvt_pk_bf16_f32 v40, v48, v49
    v_cvt_pk_bf16_f32 v41, v50, v51
    v_cvt_pk_bf16_f32 v42, v52, v53
    v_cvt_pk_bf16_f32 v43, v54, v55
    v_cvt_pk_bf16_f32 v44, v56, v57
    v_cvt_pk_bf16_f32 v45, v58, v59
    s_mul_i32 s47, s46, 1280
    buffer_store_dwordx4 v[40:43], v30, s[40:43], s47 offen
    s_and_b64 exec, exec, vcc
    buffer_store_dwordx2 v[44:45], v30, s[40:43], s47 offen offset:16
attn_kernel_done:
attn_kernel_done2:
    s_endpgm
attn_kernel_rare_0_0:
    s_nop 15
    s_nop 7
    v_mov_b32 v11, v192
    v_mov_b32 v12, v192
    s_nop 1
    v_permlane32_swap_b32 v11, v12
    v_max3_f32 v11, v11, v12, 0
    v_exp_f32 v12, -v11
    v_sub_f32 v128, v128, v11
    v_sub_f32 v129, v129, v11
    v_sub_f32 v130, v130, v11
    v_sub_f32 v131, v131, v11
    v_sub_f32 v132, v132, v11
    v_sub_f32 v133, v133, v11
    v_sub_f32 v134, v134, v11
    v_sub_f32 v135, v135, v11
    v_sub_f32 v136, v136, v11
    v_sub_f32 v137, v137, v11
    v_sub_f32 v138, v138, v11
    v_sub_f32 v139, v139, v11
    v_sub_f32 v140, v140, v11
    v_sub_f32 v141, v141, v11
    v_sub_f32 v142, v142, v11
    v_sub_f32 v143, v143, v11
    v_sub_f32 v64, v64, v11
    v_sub_f32 v65, v65, v11
    v_sub_f32 v66, v66, v11
    v_sub_f32 v67, v67, v11
    v_sub_f32 v68, v68, v11
    v_sub_f32 v69, v69, v11
    v_sub_f32 v70, v70, v11
    v_sub_f32 v71, v71, v11
    v_sub_f32 v72, v72, v11
    v_sub_f32 v73, v73, v11
    v_sub_f32 v74, v74, v11
    v_sub_f32 v75, v75, v11
    v_sub_f32 v76, v76, v11
    v_sub_f32 v77, v77, v11
    v_sub_f32 v78, v78, v11
    v_sub_f32 v79, v79, v11
    v_mul_f32 v96, v96, v12
    v_mul_f32 v97, v97, v12
    v_mul_f32 v98, v98, v12
    v_mul_f32 v99, v99, v12
    v_mul_f32 v100, v100, v12
    v_mul_f32 v101, v101, v12
    v_mul_f32 v102, v102, v12
    v_mul_f32 v103, v103, v12
    v_mul_f32 v104, v104, v12
    v_mul_f32 v105, v105, v12
    v_mul_f32 v106, v106, v12
    v_mul_f32 v107, v107, v12
    v_mul_f32 v108, v108, v12
    v_mul_f32 v109, v109, v12
    v_mul_f32 v110, v110, v12
    v_mul_f32 v111, v111, v12
    s_nop 1
    s_branch attn_kernel_back_0_0
attn_kernel_rare_0_1:
    s_nop 15
    s_nop 7
    v_mov_b32 v11, v193
    v_mov_b32 v12, v193
    s_nop 1
    v_permlane32_swap_b32 v11, v12
    v_max3_f32 v11, v11, v12, 0
    v_exp_f32 v12, -v11
    v_sub_f32 v160, v160, v11
    v_sub_f32 v161, v161, v11
    v_sub_f32 v162, v162, v11
    v_sub_f32 v163, v163, v11
    v_sub_f32 v164, v164, v11
    v_sub_f32 v165, v165, v11
    v_sub_f32 v166, v166, v11
    v_sub_f32 v167, v167, v11
    v_sub_f32 v168, v168, v11
    v_sub_f32 v169, v169, v11
    v_sub_f32 v170, v170, v11
    v_sub_f32 v171, v171, v11
    v_sub_f32 v172, v172, v11
    v_sub_f32 v173, v173, v11
    v_sub_f32 v174, v174, v11
    v_sub_f32 v175, v175, v11
    v_sub_f32 v80, v80, v11
    v_sub_f32 v81, v81, v11
    v_sub_f32 v82, v82, v11
    v_sub_f32 v83, v83, v11
    v_sub_f32 v84, v84, v11
    v_sub_f32 v85, v85, v11
    v_sub_f32 v86, v86, v11
    v_sub_f32 v87, v87, v11
    v_sub_f32 v88, v88, v11
    v_sub_f32 v89, v89, v11
    v_sub_f32 v90, v90, v11
    v_sub_f32 v91, v91, v11
    v_sub_f32 v92, v92, v11
    v_sub_f32 v93, v93, v11
    v_sub_f32 v94, v94, v11
    v_sub_f32 v95, v95, v11
    v_mul_f32 v112, v112, v12
    v_mul_f32 v113, v113, v12
    v_mul_f32 v114, v114, v12
    v_mul_f32 v115, v115, v12
    v_mul_f32 v116, v116, v12
    v_mul_f32 v117, v117, v12
    v_mul_f32 v118, v118, v12
    v_mul_f32 v119, v119, v12
    v_mul_f32 v120, v120, v12
    v_mul_f32 v121, v121, v12
    v_mul_f32 v122, v122, v12
    v_mul_f32 v123, v123, v12
    v_mul_f32 v124, v124, v12
    v_mul_f32 v125, v125, v12
    v_mul_f32 v126, v126, v12
    v_mul_f32 v127, v127, v12
    s_nop 1
    s_branch attn_kernel_back_0_1
attn_kernel_rare_1_0:
    s_nop 15
    s_nop 7
    v_mov_b32 v11, v192
    v_mov_b32 v12, v192
    s_nop 1
    v_permlane32_swap_b32 v11, v12
    v_max3_f32 v11, v11, v12, 0
    v_exp_f32 v12, -v11
    v_sub_f32 v144, v144, v11
    v_sub_f32 v145, v145, v11
    v_sub_f32 v146, v146, v11
    v_sub_f32 v147, v147, v11
    v_sub_f32 v148, v148, v11
    v_sub_f32 v149, v149, v11
    v_sub_f32 v150, v150, v11
    v_sub_f32 v151, v151, v11
    v_sub_f32 v152, v152, v11
    v_sub_f32 v153, v153, v11
    v_sub_f32 v154, v154, v11
    v_sub_f32 v155, v155, v11
    v_sub_f32 v156, v156, v11
    v_sub_f32 v157, v157, v11
    v_sub_f32 v158, v158, v11
    v_sub_f32 v159, v159, v11
    v_sub_f32 v64, v64, v11
    v_sub_f32 v65, v65, v11
    v_sub_f32 v66, v66, v11
    v_sub_f32 v67, v67, v11
    v_sub_f32 v68, v68, v11
    v_sub_f32 v69, v69, v11
    v_sub_f32 v70, v70, v11
    v_sub_f32 v71, v71, v11
    v_sub_f32 v72, v72, v11
    v_sub_f32 v73, v73, v11
    v_sub_f32 v74, v74, v11
    v_sub_f32 v75, v75, v11
    v_sub_f32 v76, v76, v11
    v_sub_f32 v77, v77, v11
    v_sub_f32 v78, v78, v11
    v_sub_f32 v79, v79, v11
    v_mul_f32 v96, v96, v12
    v_mul_f32 v97, v97, v12
    v_mul_f32 v98, v98, v12
    v_mul_f32 v99, v99, v12
    v_mul_f32 v100, v100, v12
    v_mul_f32 v101, v101, v12
    v_mul_f32 v102, v102, v12
    v_mul_f32 v103, v103, v12
    v_mul_f32 v104, v104, v12
    v_mul_f32 v105, v105, v12
    v_mul_f32 v106, v106, v12
    v_mul_f32 v107, v107, v12
    v_mul_f32 v108, v108, v12
    v_mul_f32 v109, v109, v12
    v_mul_f32 v110, v110, v12
    v_mul_f32 v111, v111, v12
    s_nop 1
    s_branch attn_kernel_back_1_0
attn_kernel_rare_1_1:
    s_nop 15
    s_nop 7
    v_mov_b32 v11, v193
    v_mov_b32 v12, v193
    s_nop 1
    v_permlane32_swap_b32 v11, v12
    v_max3_f32 v11, v11, v12, 0
    v_exp_f32 v12, -v11
    v_sub_f32 v176, v176, v11
    v_sub_f32 v177, v177, v11
    v_sub_f32 v178, v178, v11
    v_sub_f32 v179, v179, v11
    v_sub_f32 v180, v180, v11
    v_sub_f32 v181, v181, v11
    v_sub_f32 v182, v182, v11
    v_sub_f32 v183, v183, v11
    v_sub_f32 v184, v184, v11
    v_sub_f32 v185, v185, v11
    v_sub_f32 v186, v186, v11
    v_sub_f32 v187, v187, v11
    v_sub_f32 v188, v188, v11
    v_sub_f32 v189, v189, v11
    v_sub_f32 v190, v190, v11
    v_sub_f32 v191, v191, v11
    v_sub_f32 v80, v80, v11
    v_sub_f32 v81, v81, v11
    v_sub_f32 v82, v82, v11
    v_sub_f32 v83, v83, v11
    v_sub_f32 v84, v84, v11
    v_sub_f32 v85, v85, v11
    v_sub_f32 v86, v86, v11
    v_sub_f32 v87, v87, v11
    v_sub_f32 v88, v88, v11
    v_sub_f32 v89, v89, v11
    v_sub_f32 v90, v90, v11
    v_sub_f32 v91, v91, v11
    v_sub_f32 v92, v92, v11
    v_sub_f32 v93, v93, v11
    v_sub_f32 v94, v94, v11
    v_sub_f32 v95, v95, v11
    v_mul_f32 v112, v112, v12
    v_mul_f32 v113, v113, v12
    v_mul_f32 v114, v114, v12
    v_mul_f32 v115, v115, v12
    v_mul_f32 v116, v116, v12
    v_mul_f32 v117, v117, v12
    v_mul_f32 v118, v118, v12
    v_mul_f32 v119, v119, v12
    v_mul_f32 v120, v120, v12
    v_mul_f32 v121, v121, v12
    v_mul_f32 v122, v122, v12
    v_mul_f32 v123, v123, v12
    v_mul_f32 v124, v124, v12
    v_mul_f32 v125, v125, v12
    v_mul_f32 v126, v126, v12
    v_mul_f32 v127, v127, v12
    s_nop 1
    s_branch attn_kernel_back_1_1
attn_kernel_rare_2_0:
    s_nop 15
    s_nop 7
    v_mov_b32 v11, v192
    v_mov_b32 v12, v192
    s_nop 1
    v_permlane32_swap_b32 v11, v12
    v_max3_f32 v11, v11, v12, 0
    v_exp_f32 v12, -v11
    v_sub_f32 v128, v128, v11
    v_sub_f32 v129, v129, v11
    v_sub_f32 v130, v130, v11
    v_sub_f32 v131, v131, v11
    v_sub_f32 v132, v132, v11
    v_sub_f32 v133, v133, v11
    v_sub_f32 v134, v134, v11
    v_sub_f32 v135, v135, v11
    v_sub_f32 v136, v136, v11
    v_sub_f32 v137, v137, v11
    v_sub_f32 v138, v138, v11
    v_sub_f32 v139, v139, v11
    v_sub_f32 v140, v140, v11
    v_sub_f32 v141, v141, v11
    v_sub_f32 v142, v142, v11
    v_sub_f32 v143, v143, v11
    v_sub_f32 v64, v64, v11
    v_sub_f32 v65, v65, v11
    v_sub_f32 v66, v66, v11
    v_sub_f32 v67, v67, v11
    v_sub_f32 v68, v68, v11
    v_sub_f32 v69, v69, v11
    v_sub_f32 v70, v70, v11
    v_sub_f32 v71, v71, v11
    v_sub_f32 v72, v72, v11
    v_sub_f32 v73, v73, v11
    v_sub_f32 v74, v74, v11
    v_sub_f32 v75, v75, v11
    v_sub_f32 v76, v76, v11
    v_sub_f32 v77, v77, v11
    v_sub_f32 v78, v78, v11
    v_sub_f32 v79, v79, v11
    v_mul_f32 v96, v96, v12
    v_mul_f32 v97, v97, v12
    v_mul_f32 v98, v98, v12
    v_mul_f32 v99, v99, v12
    v_mul_f32 v100, v100, v12
    v_mul_f32 v101, v101, v12
    v_mul_f32 v102, v102, v12
    v_mul_f32 v103, v103, v12
    v_mul_f32 v104, v104, v12
    v_mul_f32 v105, v105, v12
    v_mul_f32 v106, v106, v12
    v_mul_f32 v107, v107, v12
    v_mul_f32 v108, v108, v12
    v_mul_f32 v109, v109, v12
    v_mul_f32 v110, v110, v12
    v_mul_f32 v111, v111, v12
    s_nop 1
    s_branch attn_kernel_back_2_0
attn_kernel_rare_2_1:
    s_nop 15
    s_nop 7
    v_mov_b32 v11, v193
    v_mov_b32 v12, v193
    s_nop 1
    v_permlane32_swap_b32 v11, v12
    v_max3_f32 v11, v11, v12, 0
    v_exp_f32 v12, -v11
    v_sub_f32 v160, v160, v11
    v_sub_f32 v161, v161, v11
    v_sub_f32 v162, v162, v11
    v_sub_f32 v163, v163, v11
    v_sub_f32 v164, v164, v11
    v_sub_f32 v165, v165, v11
    v_sub_f32 v166, v166, v11
    v_sub_f32 v167, v167, v11
    v_sub_f32 v168, v168, v11
    v_sub_f32 v169, v169, v11
    v_sub_f32 v170, v170, v11
    v_sub_f32 v171, v171, v11
    v_sub_f32 v172, v172, v11
    v_sub_f32 v173, v173, v11
    v_sub_f32 v174, v174, v11
    v_sub_f32 v175, v175, v11
    v_sub_f32 v80, v80, v11
    v_sub_f32 v81, v81, v11
    v_sub_f32 v82, v82, v11
    v_sub_f32 v83, v83, v11
    v_sub_f32 v84, v84, v11
    v_sub_f32 v85, v85, v11
    v_sub_f32 v86, v86, v11
    v_sub_f32 v87, v87, v11
    v_sub_f32 v88, v88, v11
    v_sub_f32 v89, v89, v11
    v_sub_f32 v90, v90, v11
    v_sub_f32 v91, v91, v11
    v_sub_f32 v92, v92, v11
    v_sub_f32 v93, v93, v11
    v_sub_f32 v94, v94, v11
    v_sub_f32 v95, v95, v11
    v_mul_f32 v112, v112, v12
    v_mul_f32 v113, v113, v12
    v_mul_f32 v114, v114, v12
    v_mul_f32 v115, v115, v12
    v_mul_f32 v116, v116, v12
    v_mul_f32 v117, v117, v12
    v_mul_f32 v118, v118, v12
    v_mul_f32 v119, v119, v12
    v_mul_f32 v120, v120, v12
    v_mul_f32 v121, v121, v12
    v_mul_f32 v122, v122, v12
    v_mul_f32 v123, v123, v12
    v_mul_f32 v124, v124, v12
    v_mul_f32 v125, v125, v12
    v_mul_f32 v126, v126, v12
    v_mul_f32 v127, v127, v12
    s_nop 1
    s_branch attn_kernel_back_2_1
attn_kernel_rare_3_0:
    s_nop 15
    s_nop 7
    v_mov_b32 v11, v192
    v_mov_b32 v12, v192
    s_nop 1
    v_permlane32_swap_b32 v11, v12
    v_max3_f32 v11, v11, v12, 0
    v_exp_f32 v12, -v11
    v_sub_f32 v144, v144, v11
    v_sub_f32 v145, v145, v11
    v_sub_f32 v146, v146, v11
    v_sub_f32 v147, v147, v11
    v_sub_f32 v148, v148, v11
    v_sub_f32 v149, v149, v11
    v_sub_f32 v150, v150, v11
    v_sub_f32 v151, v151, v11
    v_sub_f32 v152, v152, v11
    v_sub_f32 v153, v153, v11
    v_sub_f32 v154, v154, v11
    v_sub_f32 v155, v155, v11
    v_sub_f32 v156, v156, v11
    v_sub_f32 v157, v157, v11
    v_sub_f32 v158, v158, v11
    v_sub_f32 v159, v159, v11
    v_sub_f32 v64, v64, v11
    v_sub_f32 v65, v65, v11
    v_sub_f32 v66, v66, v11
    v_sub_f32 v67, v67, v11
    v_sub_f32 v68, v68, v11
    v_sub_f32 v69, v69, v11
    v_sub_f32 v70, v70, v11
    v_sub_f32 v71, v71, v11
    v_sub_f32 v72, v72, v11
    v_sub_f32 v73, v73, v11
    v_sub_f32 v74, v74, v11
    v_sub_f32 v75, v75, v11
    v_sub_f32 v76, v76, v11
    v_sub_f32 v77, v77, v11
    v_sub_f32 v78, v78, v11
    v_sub_f32 v79, v79, v11
    v_mul_f32 v96, v96, v12
    v_mul_f32 v97, v97, v12
    v_mul_f32 v98, v98, v12
    v_mul_f32 v99, v99, v12
    v_mul_f32 v100, v100, v12
    v_mul_f32 v101, v101, v12
    v_mul_f32 v102, v102, v12
    v_mul_f32 v103, v103, v12
    v_mul_f32 v104, v104, v12
    v_mul_f32 v105, v105, v12
    v_mul_f32 v106, v106, v12
    v_mul_f32 v107, v107, v12
    v_mul_f32 v108, v108, v12
    v_mul_f32 v109, v109, v12
    v_mul_f32 v110, v110, v12
    v_mul_f32 v111, v111, v12
    s_nop 1
    s_branch attn_kernel_back_3_0
attn_kernel_rare_3_1:
    s_nop 15
    s_nop 7
    v_mov_b32 v11, v193
    v_mov_b32 v12, v193
    s_nop 1
    v_permlane32_swap_b32 v11, v12
    v_max3_f32 v11, v11, v12, 0
    v_exp_f32 v12, -v11
    v_sub_f32 v176, v176, v11
    v_sub_f32 v177, v177, v11
    v_sub_f32 v178, v178, v11
    v_sub_f32 v179, v179, v11
    v_sub_f32 v180, v180, v11
    v_sub_f32 v181, v181, v11
    v_sub_f32 v182, v182, v11
    v_sub_f32 v183, v183, v11
    v_sub_f32 v184, v184, v11
    v_sub_f32 v185, v185, v11
    v_sub_f32 v186, v186, v11
    v_sub_f32 v187, v187, v11
    v_sub_f32 v188, v188, v11
    v_sub_f32 v189, v189, v11
    v_sub_f32 v190, v190, v11
    v_sub_f32 v191, v191, v11
    v_sub_f32 v80, v80, v11
    v_sub_f32 v81, v81, v11
    v_sub_f32 v82, v82, v11
    v_sub_f32 v83, v83, v11
    v_sub_f32 v84, v84, v11
    v_sub_f32 v85, v85, v11
    v_sub_f32 v86, v86, v11
    v_sub_f32 v87, v87, v11
    v_sub_f32 v88, v88, v11
    v_sub_f32 v89, v89, v11
    v_sub_f32 v90, v90, v11
    v_sub_f32 v91, v91, v11
    v_sub_f32 v92, v92, v11
    v_sub_f32 v93, v93, v11
    v_sub_f32 v94, v94, v11
    v_sub_f32 v95, v95, v11
    v_mul_f32 v112, v112, v12
    v_mul_f32 v113, v113, v12
    v_mul_f32 v114, v114, v12
    v_mul_f32 v115, v115, v12
    v_mul_f32 v116, v116, v12
    v_mul_f32 v117, v117, v12
    v_mul_f32 v118, v118, v12
    v_mul_f32 v119, v119, v12
    v_mul_f32 v120, v120, v12
    v_mul_f32 v121, v121, v12
    v_mul_f32 v122, v122, v12
    v_mul_f32 v123, v123, v12
    v_mul_f32 v124, v124, v12
    v_mul_f32 v125, v125, v12
    v_mul_f32 v126, v126, v12
    v_mul_f32 v127, v127, v12
    s_nop 1
    s_branch attn_kernel_back_3_1
.globl oproj_kernel
.p2align 8
.type oproj_kernel,@function
oproj_kernel:
    s_cmp_ge_u32 s2, 256
    s_cbranch_scc1 oproj_kernel_done2
    s_load_dwordx2 s[4:5], s[0:1], 16
    s_load_dwordx2 s[6:7], s[0:1], 40
    s_load_dwordx2 s[8:9], s[0:1], 48
    s_load_dwordx2 s[36:37], s[0:1], 64
    v_lshrrev_b32 v1, 6, v0
    v_and_b32 v2, 63, v0
    s_and_b32 s31, s2, 7
    v_readfirstlane_b32 s24, v1
    s_lshr_b32 s32, s2, 3
    s_and_b32 s27, s31, 1
    s_lshr_b32 s25, s31, 1
    s_lshl_b32 s25, s25, 3
    s_lshr_b32 s33, s32, 2
    s_add_u32 s25, s25, s33
    s_and_b32 s26, s32, 3
    s_min_u32 s31, s24, 3
    s_lshl_b32 s28, s31, 11
    s_lshl_b32 s31, s31, 4
    v_lshrrev_b32 v3, 3, v2
    v_add_u32 v3, s31, v3
    v_and_b32 v4, 7, v2
    s_mov_b32 s32, 1280
    v_add_u32 v5, 0, v3
    v_bfe_u32 v6, v5, 1, 3
    v_xor_b32 v6, v6, v4
    v_lshlrev_b32 v6, 4, v6
    v_mad_u32_u24 v8, v5, s32, v6
    v_add_u32 v5, 8, v3
    v_bfe_u32 v6, v5, 1, 3
    v_xor_b32 v6, v6, v4
    v_lshlrev_b32 v6, 4, v6
    v_mad_u32_u24 v9, v5, s32, v6
    s_lshl_b32 s29, s24, 12
    s_add_u32 s29, s29, 8192
    s_lshl_b32 s31, s24, 8
    v_add_u32 v3, s31, v2
    s_mov_b32 s33, 3277
    v_add_u32 v4, 0, v3
    v_mul_u32_u24 v5, s33, v4
    v_lshrrev_b32 v5, 16, v5
    v_mul_u32_u24 v6, 20, v5
    v_sub_u32 v6, v4, v6
    v_lshlrev_b32 v6, 4, v6
    v_mad_u32_u24 v10, v5, s32, v6
    v_add_u32 v4, 64, v3
    v_mul_u32_u24 v5, s33, v4
    v_lshrrev_b32 v5, 16, v5
    v_mul_u32_u24 v6, 20, v5
    v_sub_u32 v6, v4, v6
    v_lshlrev_b32 v6, 4, v6
    v_mad_u32_u24 v11, v5, s32, v6
    v_add_u32 v4, 128, v3
    v_mul_u32_u24 v5, s33, v4
    v_lshrrev_b32 v5, 16, v5
    v_mul_u32_u24 v6, 20, v5
    v_sub_u32 v6, v4, v6
    v_lshlrev_b32 v6, 4, v6
    v_mad_u32_u24 v12, v5, s32, v6
    v_add_u32 v4, 192, v3
    v_mul_u32_u24 v5, s33, v4
    v_lshrrev_b32 v5, 16, v5
    v_mul_u32_u24 v6, 20, v5
    v_sub_u32 v6, v4, v6
    v_lshlrev_b32 v6, 4, v6
    v_mad_u32_u24 v13, v5, s32, v6
    s_waitcnt lgkmcnt(0)
    s_cmp_eq_u32 s27, 0
    s_cselect_b64 s[6:7], s[4:5], s[6:7]
    s_mov_b32 s32, 25165824
    s_cselect_b32 s32, 20971520, s32
    s_mul_i32 s31, s25, 81920
    s_add_u32 s31, s31, s32
    s_add_u32 s12, s36, s31
    s_addc_u32 s13, s37, 0
    s_mov_b32 s14, 81920
    s_mov_b32 s15, 0x00020000
    s_mul_i32 s31, s26, 320
    s_add_u32 s16, s6, s31
    s_addc_u32 s17, s7, 0
    s_sub_u32 s18, 819200, s31
    s_mov_b32 s19, 0x00020000
    s_mov_b32 s20, s8
    s_mov_b32 s21, s9
    s_mov_b32 s22, 5242880
    s_mov_b32 s23, 0x00020000
    s_lshr_b32 s42, s2, 3
    s_mul_i32 s42, s42, 3
    s_mul_i32 s43, s42, 6554
    s_lshr_b32 s43, s43, 16
    s_mul_i32 s43, s43, 10
    s_sub_u32 s42, s42, s43
    s_mov_b32 s42, 0
    s_lshl_b32 s30, s42, 7
    s_add_u32 m0, s28, 0
    s_nop 0
    buffer_load_dwordx4 v8, s[12:15], s30 offen lds
    s_add_u32 m0, s28, 1024
    s_nop 0
    buffer_load_dwordx4 v9, s[12:15], s30 offen lds
    s_mul_i32 s30, s42, 81920
    s_add_u32 m0, s29, 0
    s_nop 0
    buffer_load_dwordx4 v10, s[16:19], s30 offen lds
    s_add_u32 m0, s29, 1024
    s_nop 0
    buffer_load_dwordx4 v11, s[16:19], s30 offen lds
    s_add_u32 m0, s29, 2048
    s_nop 0
    buffer_load_dwordx4 v12, s[16:19], s30 offen lds
    s_add_u32 m0, s29, 3072
    s_nop 0
    buffer_load_dwordx4 v13, s[16:19], s30 offen lds
    s_add_u32 s42, s42, 1
    s_cmp_eq_u32 s42, 10
    s_cselect_b32 s42, 0, s42
    s_lshl_b32 s30, s42, 7
    s_add_u32 m0, s28, 28672
    s_nop 0
    buffer_load_dwordx4 v8, s[12:15], s30 offen lds
    s_add_u32 m0, s28, 29696
    s_nop 0
    buffer_load_dwordx4 v9, s[12:15], s30 offen lds
    s_mul_i32 s30, s42, 81920
    s_add_u32 m0, s29, 28672
    s_nop 0
    buffer_load_dwordx4 v10, s[16:19], s30 offen lds
    s_add_u32 m0, s29, 29696
    s_nop 0
    buffer_load_dwordx4 v11, s[16:19], s30 offen lds
    s_add_u32 m0, s29, 30720
    s_nop 0
    buffer_load_dwordx4 v12, s[16:19], s30 offen lds
    s_add_u32 m0, s29, 31744
    s_nop 0
    buffer_load_dwordx4 v13, s[16:19], s30 offen lds
    s_add_u32 s42, s42, 1
    s_cmp_eq_u32 s42, 10
    s_cselect_b32 s42, 0, s42
    s_lshl_b32 s30, s42, 7
    s_add_u32 m0, s28, 57344
    s_nop 0
    buffer_load_dwordx4 v8, s[12:15], s30 offen lds
    s_add_u32 m0, s28, 58368
    s_nop 0
    buffer_load_dwordx4 v9, s[12:15], s30 offen lds
    s_mul_i32 s30, s42, 81920
    s_add_u32 m0, s29, 57344
    s_nop 0
    buffer_load_dwordx4 v10, s[16:19], s30 offen lds
    s_add_u32 m0, s29, 58368
    s_nop 0
    buffer_load_dwordx4 v11, s[16:19], s30 offen lds
    s_add_u32 m0, s29, 59392
    s_nop 0
    buffer_load_dwordx4 v12, s[16:19], s30 offen lds
    s_add_u32 m0, s29, 60416
    s_nop 0
    buffer_load_dwordx4 v13, s[16:19], s30 offen lds
    s_add_u32 s42, s42, 1
    s_cmp_eq_u32 s42, 10
    s_cselect_b32 s42, 0, s42
    s_lshl_b32 s30, s42, 7
    s_add_u32 m0, s28, 86016
    s_nop 0
    buffer_load_dwordx4 v8, s[12:15], s30 offen lds
    s_add_u32 m0, s28, 87040
    s_nop 0
    buffer_load_dwordx4 v9, s[12:15], s30 offen lds
    s_mul_i32 s30, s42, 81920
    s_add_u32 m0, s29, 86016
    s_nop 0
    buffer_load_dwordx4 v10, s[16:19], s30 offen lds
    s_add_u32 m0, s29, 87040
    s_nop 0
    buffer_load_dwordx4 v11, s[16:19], s30 offen lds
    s_add_u32 m0, s29, 88064
    s_nop 0
    buffer_load_dwordx4 v12, s[16:19], s30 offen lds
    s_add_u32 m0, s29, 89088
    s_nop 0
    buffer_load_dwordx4 v13, s[16:19], s30 offen lds
    s_add_u32 s42, s42, 1
    s_cmp_eq_u32 s42, 10
    s_cselect_b32 s42, 0, s42
    v_and_b32 v3, 31, v2
    v_lshrrev_b32 v4, 5, v2
    v_bfe_u32 v5, v3, 1, 3
    v_lshlrev_b32 v3, 7, v3
    v_add_u32 v6, 0, v4
    v_xor_b32 v6, v6, v5
    v_lshl_add_u32 v16, v6, 4, v3
    v_add_u32 v20, 28672, v16
    v_add_u32 v24, 57344, v16
    v_add_u32 v28, 86016, v16
    v_add_u32 v32, 114688, v16
    v_add_u32 v6, 2, v4
    v_xor_b32 v6, v6, v5
    v_lshl_add_u32 v17, v6, 4, v3
    v_add_u32 v21, 28672, v17
    v_add_u32 v25, 57344, v17
    v_add_u32 v29, 86016, v17
    v_add_u32 v33, 114688, v17
    v_add_u32 v6, 4, v4
    v_xor_b32 v6, v6, v5
    v_lshl_add_u32 v18, v6, 4, v3
    v_add_u32 v22, 28672, v18
    v_add_u32 v26, 57344, v18
    v_add_u32 v30, 86016, v18
    v_add_u32 v34, 114688, v18
    v_add_u32 v6, 6, v4
    v_xor_b32 v6, v6, v5
    v_lshl_add_u32 v19, v6, 4, v3
    v_add_u32 v23, 28672, v19
    v_add_u32 v27, 57344, v19
    v_add_u32 v31, 86016, v19
    v_add_u32 v35, 114688, v19
    v_bfe_u32 v3, v2, 2, 2
    v_and_b32 v4, 3, v2
    v_bfe_u32 v5, v2, 4, 1
    v_lshrrev_b32 v6, 5, v2
    v_lshl_add_u32 v6, v6, 3, v3
    v_mul_u32_u24 v6, 320, v6
    v_lshlrev_b32 v4, 3, v4
    v_lshl_add_u32 v4, v5, 5, v4
    s_lshl_b32 s31, s24, 6
    v_add3_u32 v6, v6, v4, s31
    v_add_u32 v36, 8192, v6
    v_add_u32 v37, 28672, v36
    v_add_u32 v38, 57344, v36
    v_add_u32 v39, 86016, v36
    v_add_u32 v40, 114688, v36
    v_mov_b32 v68, 0
    v_mov_b32 v69, 0
    v_mov_b32 v70, 0
    v_mov_b32 v71, 0
    v_mov_b32 v72, 0
    v_mov_b32 v73, 0
    v_mov_b32 v74, 0
    v_mov_b32 v75, 0
    v_mov_b32 v76, 0
    v_mov_b32 v77, 0
    v_mov_b32 v78, 0
    v_mov_b32 v79, 0
    v_mov_b32 v80, 0
    v_mov_b32 v81, 0
    v_mov_b32 v82, 0
    v_mov_b32 v83, 0
    v_mov_b32 v84, 0
    v_mov_b32 v85, 0
    v_mov_b32 v86, 0
    v_mov_b32 v87, 0
    v_mov_b32 v88, 0
    v_mov_b32 v89, 0
    v_mov_b32 v90, 0
    v_mov_b32 v91, 0
    v_mov_b32 v92, 0
    v_mov_b32 v93, 0
    v_mov_b32 v94, 0
    v_mov_b32 v95, 0
    v_mov_b32 v96, 0
    v_mov_b32 v97, 0
    v_mov_b32 v98, 0
    v_mov_b32 v99, 0
    s_waitcnt vmcnt(18)
    s_barrier
    ds_read_b128 v[44:47], v16 offset:0
    ds_read_b128 v[48:51], v16 offset:4096
    ds_read_b64_tr_b16 v[60:61], v36 offset:0
    ds_read_b64_tr_b16 v[62:63], v36 offset:1280
    s_lshl_b32 s30, s42, 7
    s_add_u32 m0, s28, 114688
    s_nop 0
    buffer_load_dwordx4 v8, s[12:15], s30 offen lds
    s_add_u32 m0, s28, 115712
    s_nop 0
    buffer_load_dwordx4 v9, s[12:15], s30 offen lds
    s_mul_i32 s30, s42, 81920
    s_add_u32 m0, s29, 114688
    s_nop 0
    buffer_load_dwordx4 v10, s[16:19], s30 offen lds
    s_add_u32 m0, s29, 115712
    s_nop 0
    buffer_load_dwordx4 v11, s[16:19], s30 offen lds
    s_add_u32 m0, s29, 116736
    s_nop 0
    buffer_load_dwordx4 v12, s[16:19], s30 offen lds
    s_add_u32 m0, s29, 117760
    s_nop 0
    buffer_load_dwordx4 v13, s[16:19], s30 offen lds
    s_add_u32 s42, s42, 1
    s_cmp_eq_u32 s42, 10
    s_cselect_b32 s42, 0, s42
    ds_read_b128 v[52:55], v17 offset:0
    ds_read_b128 v[56:59], v17 offset:4096
    ds_read_b64_tr_b16 v[64:65], v36 offset:5120
    ds_read_b64_tr_b16 v[66:67], v36 offset:6400
    s_waitcnt lgkmcnt(4)
    v_mfma_f32_32x32x16_bf16 v[68:83], v[60:63], v[44:47], v[68:83]
    v_mfma_f32_32x32x16_bf16 v[84:99], v[60:63], v[48:51], v[84:99]
    ds_read_b128 v[44:47], v18 offset:0
    ds_read_b128 v[48:51], v18 offset:4096
    ds_read_b64_tr_b16 v[60:61], v36 offset:10240
    ds_read_b64_tr_b16 v[62:63], v36 offset:11520
    s_waitcnt lgkmcnt(4)
    v_mfma_f32_32x32x16_bf16 v[68:83], v[64:67], v[52:55], v[68:83]
    v_mfma_f32_32x32x16_bf16 v[84:99], v[64:67], v[56:59], v[84:99]
    ds_read_b128 v[52:55], v19 offset:0
    ds_read_b128 v[56:59], v19 offset:4096
    ds_read_b64_tr_b16 v[64:65], v36 offset:15360
    ds_read_b64_tr_b16 v[66:67], v36 offset:16640
    s_waitcnt lgkmcnt(4)
    v_mfma_f32_32x32x16_bf16 v[68:83], v[60:63], v[44:47], v[68:83]
    v_mfma_f32_32x32x16_bf16 v[84:99], v[60:63], v[48:51], v[84:99]
    s_waitcnt lgkmcnt(0)
    v_mfma_f32_32x32x16_bf16 v[68:83], v[64:67], v[52:55], v[68:83]
    v_mfma_f32_32x32x16_bf16 v[84:99], v[64:67], v[56:59], v[84:99]
    s_waitcnt vmcnt(18)
    s_barrier
    ds_read_b128 v[44:47], v20 offset:0
    ds_read_b128 v[48:51], v20 offset:4096
    ds_read_b64_tr_b16 v[60:61], v37 offset:0
    ds_read_b64_tr_b16 v[62:63], v37 offset:1280
    s_lshl_b32 s30, s42, 7
    s_add_u32 m0, s28, 0
    s_nop 0
    buffer_load_dwordx4 v8, s[12:15], s30 offen lds
    s_add_u32 m0, s28, 1024
    s_nop 0
    buffer_load_dwordx4 v9, s[12:15], s30 offen lds
    s_mul_i32 s30, s42, 81920
    s_add_u32 m0, s29, 0
    s_nop 0
    buffer_load_dwordx4 v10, s[16:19], s30 offen lds
    s_add_u32 m0, s29, 1024
    s_nop 0
    buffer_load_dwordx4 v11, s[16:19], s30 offen lds
    s_add_u32 m0, s29, 2048
    s_nop 0
    buffer_load_dwordx4 v12, s[16:19], s30 offen lds
    s_add_u32 m0, s29, 3072
    s_nop 0
    buffer_load_dwordx4 v13, s[16:19], s30 offen lds
    s_add_u32 s42, s42, 1
    s_cmp_eq_u32 s42, 10
    s_cselect_b32 s42, 0, s42
    ds_read_b128 v[52:55], v21 offset:0
    ds_read_b128 v[56:59], v21 offset:4096
    ds_read_b64_tr_b16 v[64:65], v37 offset:5120
    ds_read_b64_tr_b16 v[66:67], v37 offset:6400
    s_waitcnt lgkmcnt(4)
    v_mfma_f32_32x32x16_bf16 v[68:83], v[60:63], v[44:47], v[68:83]
    v_mfma_f32_32x32x16_bf16 v[84:99], v[60:63], v[48:51], v[84:99]
    ds_read_b128 v[44:47], v22 offset:0
    ds_read_b128 v[48:51], v22 offset:4096
    ds_read_b64_tr_b16 v[60:61], v37 offset:10240
    ds_read_b64_tr_b16 v[62:63], v37 offset:11520
    s_waitcnt lgkmcnt(4)
    v_mfma_f32_32x32x16_bf16 v[68:83], v[64:67], v[52:55], v[68:83]
    v_mfma_f32_32x32x16_bf16 v[84:99], v[64:67], v[56:59], v[84:99]
    ds_read_b128 v[52:55], v23 offset:0
    ds_read_b128 v[56:59], v23 offset:4096
    ds_read_b64_tr_b16 v[64:65], v37 offset:15360
    ds_read_b64_tr_b16 v[66:67], v37 offset:16640
    s_waitcnt lgkmcnt(4)
    v_mfma_f32_32x32x16_bf16 v[68:83], v[60:63], v[44:47], v[68:83]
    v_mfma_f32_32x32x16_bf16 v[84:99], v[60:63], v[48:51], v[84:99]
    s_waitcnt lgkmcnt(0)
    v_mfma_f32_32x32x16_bf16 v[68:83], v[64:67], v[52:55], v[68:83]
    v_mfma_f32_32x32x16_bf16 v[84:99], v[64:67], v[56:59], v[84:99]
    s_waitcnt vmcnt(18)
    s_barrier
    ds_read_b128 v[44:47], v24 offset:0
    ds_read_b128 v[48:51], v24 offset:4096
    ds_read_b64_tr_b16 v[60:61], v38 offset:0
    ds_read_b64_tr_b16 v[62:63], v38 offset:1280
    s_lshl_b32 s30, s42, 7
    s_add_u32 m0, s28, 28672
    s_nop 0
    buffer_load_dwordx4 v8, s[12:15], s30 offen lds
    s_add_u32 m0, s28, 29696
    s_nop 0
    buffer_load_dwordx4 v9, s[12:15], s30 offen lds
    s_mul_i32 s30, s42, 81920
    s_add_u32 m0, s29, 28672
    s_nop 0
    buffer_load_dwordx4 v10, s[16:19], s30 offen lds
    s_add_u32 m0, s29, 29696
    s_nop 0
    buffer_load_dwordx4 v11, s[16:19], s30 offen lds
    s_add_u32 m0, s29, 30720
    s_nop 0
    buffer_load_dwordx4 v12, s[16:19], s30 offen lds
    s_add_u32 m0, s29, 31744
    s_nop 0
    buffer_load_dwordx4 v13, s[16:19], s30 offen lds
    s_add_u32 s42, s42, 1
    s_cmp_eq_u32 s42, 10
    s_cselect_b32 s42, 0, s42
    ds_read_b128 v[52:55], v25 offset:0
    ds_read_b128 v[56:59], v25 offset:4096
    ds_read_b64_tr_b16 v[64:65], v38 offset:5120
    ds_read_b64_tr_b16 v[66:67], v38 offset:6400
    s_waitcnt lgkmcnt(4)
    v_mfma_f32_32x32x16_bf16 v[68:83], v[60:63], v[44:47], v[68:83]
    v_mfma_f32_32x32x16_bf16 v[84:99], v[60:63], v[48:51], v[84:99]
    ds_read_b128 v[44:47], v26 offset:0
    ds_read_b128 v[48:51], v26 offset:4096
    ds_read_b64_tr_b16 v[60:61], v38 offset:10240
    ds_read_b64_tr_b16 v[62:63], v38 offset:11520
    s_waitcnt lgkmcnt(4)
    v_mfma_f32_32x32x16_bf16 v[68:83], v[64:67], v[52:55], v[68:83]
    v_mfma_f32_32x32x16_bf16 v[84:99], v[64:67], v[56:59], v[84:99]
    ds_read_b128 v[52:55], v27 offset:0
    ds_read_b128 v[56:59], v27 offset:4096
    ds_read_b64_tr_b16 v[64:65], v38 offset:15360
    ds_read_b64_tr_b16 v[66:67], v38 offset:16640
    s_waitcnt lgkmcnt(4)
    v_mfma_f32_32x32x16_bf16 v[68:83], v[60:63], v[44:47], v[68:83]
    v_mfma_f32_32x32x16_bf16 v[84:99], v[60:63], v[48:51], v[84:99]
    s_waitcnt lgkmcnt(0)
    v_mfma_f32_32x32x16_bf16 v[68:83], v[64:67], v[52:55], v[68:83]
    v_mfma_f32_32x32x16_bf16 v[84:99], v[64:67], v[56:59], v[84:99]
    s_waitcnt vmcnt(18)
    s_barrier
    ds_read_b128 v[44:47], v28 offset:0
    ds_read_b128 v[48:51], v28 offset:4096
    ds_read_b64_tr_b16 v[60:61], v39 offset:0
    ds_read_b64_tr_b16 v[62:63], v39 offset:1280
    s_lshl_b32 s30, s42, 7
    s_add_u32 m0, s28, 57344
    s_nop 0
    buffer_load_dwordx4 v8, s[12:15], s30 offen lds
    s_add_u32 m0, s28, 58368
    s_nop 0
    buffer_load_dwordx4 v9, s[12:15], s30 offen lds
    s_mul_i32 s30, s42, 81920
    s_add_u32 m0, s29, 57344
    s_nop 0
    buffer_load_dwordx4 v10, s[16:19], s30 offen lds
    s_add_u32 m0, s29, 58368
    s_nop 0
    buffer_load_dwordx4 v11, s[16:19], s30 offen lds
    s_add_u32 m0, s29, 59392
    s_nop 0
    buffer_load_dwordx4 v12, s[16:19], s30 offen lds
    s_add_u32 m0, s29, 60416
    s_nop 0
    buffer_load_dwordx4 v13, s[16:19], s30 offen lds
    s_add_u32 s42, s42, 1
    s_cmp_eq_u32 s42, 10
    s_cselect_b32 s42, 0, s42
    ds_read_b128 v[52:55], v29 offset:0
    ds_read_b128 v[56:59], v29 offset:4096
    ds_read_b64_tr_b16 v[64:65], v39 offset:5120
    ds_read_b64_tr_b16 v[66:67], v39 offset:6400
    s_waitcnt lgkmcnt(4)
    v_mfma_f32_32x32x16_bf16 v[68:83], v[60:63], v[44:47], v[68:83]
    v_mfma_f32_32x32x16_bf16 v[84:99], v[60:63], v[48:51], v[84:99]
    ds_read_b128 v[44:47], v30 offset:0
    ds_read_b128 v[48:51], v30 offset:4096
    ds_read_b64_tr_b16 v[60:61], v39 offset:10240
    ds_read_b64_tr_b16 v[62:63], v39 offset:11520
    s_waitcnt lgkmcnt(4)
    v_mfma_f32_32x32x16_bf16 v[68:83], v[64:67], v[52:55], v[68:83]
    v_mfma_f32_32x32x16_bf16 v[84:99], v[64:67], v[56:59], v[84:99]
    ds_read_b128 v[52:55], v31 offset:0
    ds_read_b128 v[56:59], v31 offset:4096
    ds_read_b64_tr_b16 v[64:65], v39 offset:15360
    ds_read_b64_tr_b16 v[66:67], v39 offset:16640
    s_waitcnt lgkmcnt(4)
    v_mfma_f32_32x32x16_bf16 v[68:83], v[60:63], v[44:47], v[68:83]
    v_mfma_f32_32x32x16_bf16 v[84:99], v[60:63], v[48:51], v[84:99]
    s_waitcnt lgkmcnt(0)
    v_mfma_f32_32x32x16_bf16 v[68:83], v[64:67], v[52:55], v[68:83]
    v_mfma_f32_32x32x16_bf16 v[84:99], v[64:67], v[56:59], v[84:99]
    s_waitcnt vmcnt(18)
    s_barrier
    ds_read_b128 v[44:47], v32 offset:0
    ds_read_b128 v[48:51], v32 offset:4096
    ds_read_b64_tr_b16 v[60:61], v40 offset:0
    ds_read_b64_tr_b16 v[62:63], v40 offset:1280
    s_lshl_b32 s30, s42, 7
    s_add_u32 m0, s28, 86016
    s_nop 0
    buffer_load_dwordx4 v8, s[12:15], s30 offen lds
    s_add_u32 m0, s28, 87040
    s_nop 0
    buffer_load_dwordx4 v9, s[12:15], s30 offen lds
    s_mul_i32 s30, s42, 81920
    s_add_u32 m0, s29, 86016
    s_nop 0
    buffer_load_dwordx4 v10, s[16:19], s30 offen lds
    s_add_u32 m0, s29, 87040
    s_nop 0
    buffer_load_dwordx4 v11, s[16:19], s30 offen lds
    s_add_u32 m0, s29, 88064
    s_nop 0
    buffer_load_dwordx4 v12, s[16:19], s30 offen lds
    s_add_u32 m0, s29, 89088
    s_nop 0
    buffer_load_dwordx4 v13, s[16:19], s30 offen lds
    s_add_u32 s42, s42, 1
    s_cmp_eq_u32 s42, 10
    s_cselect_b32 s42, 0, s42
    ds_read_b128 v[52:55], v33 offset:0
    ds_read_b128 v[56:59], v33 offset:4096
    ds_read_b64_tr_b16 v[64:65], v40 offset:5120
    ds_read_b64_tr_b16 v[66:67], v40 offset:6400
    s_waitcnt lgkmcnt(4)
    v_mfma_f32_32x32x16_bf16 v[68:83], v[60:63], v[44:47], v[68:83]
    v_mfma_f32_32x32x16_bf16 v[84:99], v[60:63], v[48:51], v[84:99]
    ds_read_b128 v[44:47], v34 offset:0
    ds_read_b128 v[48:51], v34 offset:4096
    ds_read_b64_tr_b16 v[60:61], v40 offset:10240
    ds_read_b64_tr_b16 v[62:63], v40 offset:11520
    s_waitcnt lgkmcnt(4)
    v_mfma_f32_32x32x16_bf16 v[68:83], v[64:67], v[52:55], v[68:83]
    v_mfma_f32_32x32x16_bf16 v[84:99], v[64:67], v[56:59], v[84:99]
    ds_read_b128 v[52:55], v35 offset:0
    ds_read_b128 v[56:59], v35 offset:4096
    ds_read_b64_tr_b16 v[64:65], v40 offset:15360
    ds_read_b64_tr_b16 v[66:67], v40 offset:16640
    s_waitcnt lgkmcnt(4)
    v_mfma_f32_32x32x16_bf16 v[68:83], v[60:63], v[44:47], v[68:83]
    v_mfma_f32_32x32x16_bf16 v[84:99], v[60:63], v[48:51], v[84:99]
    s_waitcnt lgkmcnt(0)
    v_mfma_f32_32x32x16_bf16 v[68:83], v[64:67], v[52:55], v[68:83]
    v_mfma_f32_32x32x16_bf16 v[84:99], v[64:67], v[56:59], v[84:99]
    s_waitcnt vmcnt(18)
    s_barrier
    ds_read_b128 v[44:47], v16 offset:0
    ds_read_b128 v[48:51], v16 offset:4096
    ds_read_b64_tr_b16 v[60:61], v36 offset:0
    ds_read_b64_tr_b16 v[62:63], v36 offset:1280
    s_lshl_b32 s30, s42, 7
    s_add_u32 m0, s28, 114688
    s_nop 0
    buffer_load_dwordx4 v8, s[12:15], s30 offen lds
    s_add_u32 m0, s28, 115712
    s_nop 0
    buffer_load_dwordx4 v9, s[12:15], s30 offen lds
    s_mul_i32 s30, s42, 81920
    s_add_u32 m0, s29, 114688
    s_nop 0
    buffer_load_dwordx4 v10, s[16:19], s30 offen lds
    s_add_u32 m0, s29, 115712
    s_nop 0
    buffer_load_dwordx4 v11, s[16:19], s30 offen lds
    s_add_u32 m0, s29, 116736
    s_nop 0
    buffer_load_dwordx4 v12, s[16:19], s30 offen lds
    s_add_u32 m0, s29, 117760
    s_nop 0
    buffer_load_dwordx4 v13, s[16:19], s30 offen lds
    s_add_u32 s42, s42, 1
    s_cmp_eq_u32 s42, 10
    s_cselect_b32 s42, 0, s42
    ds_read_b128 v[52:55], v17 offset:0
    ds_read_b128 v[56:59], v17 offset:4096
    ds_read_b64_tr_b16 v[64:65], v36 offset:5120
    ds_read_b64_tr_b16 v[66:67], v36 offset:6400
    s_waitcnt lgkmcnt(4)
    v_mfma_f32_32x32x16_bf16 v[68:83], v[60:63], v[44:47], v[68:83]
    v_mfma_f32_32x32x16_bf16 v[84:99], v[60:63], v[48:51], v[84:99]
    ds_read_b128 v[44:47], v18 offset:0
    ds_read_b128 v[48:51], v18 offset:4096
    ds_read_b64_tr_b16 v[60:61], v36 offset:10240
    ds_read_b64_tr_b16 v[62:63], v36 offset:11520
    s_waitcnt lgkmcnt(4)
    v_mfma_f32_32x32x16_bf16 v[68:83], v[64:67], v[52:55], v[68:83]
    v_mfma_f32_32x32x16_bf16 v[84:99], v[64:67], v[56:59], v[84:99]
    ds_read_b128 v[52:55], v19 offset:0
    ds_read_b128 v[56:59], v19 offset:4096
    ds_read_b64_tr_b16 v[64:65], v36 offset:15360
    ds_read_b64_tr_b16 v[66:67], v36 offset:16640
    s_waitcnt lgkmcnt(4)
    v_mfma_f32_32x32x16_bf16 v[68:83], v[60:63], v[44:47], v[68:83]
    v_mfma_f32_32x32x16_bf16 v[84:99], v[60:63], v[48:51], v[84:99]
    s_waitcnt lgkmcnt(0)
    v_mfma_f32_32x32x16_bf16 v[68:83], v[64:67], v[52:55], v[68:83]
    v_mfma_f32_32x32x16_bf16 v[84:99], v[64:67], v[56:59], v[84:99]
    s_waitcnt vmcnt(18)
    s_barrier
    ds_read_b128 v[44:47], v20 offset:0
    ds_read_b128 v[48:51], v20 offset:4096
    ds_read_b64_tr_b16 v[60:61], v37 offset:0
    ds_read_b64_tr_b16 v[62:63], v37 offset:1280
    ds_read_b128 v[52:55], v21 offset:0
    ds_read_b128 v[56:59], v21 offset:4096
    ds_read_b64_tr_b16 v[64:65], v37 offset:5120
    ds_read_b64_tr_b16 v[66:67], v37 offset:6400
    s_waitcnt lgkmcnt(4)
    v_mfma_f32_32x32x16_bf16 v[68:83], v[60:63], v[44:47], v[68:83]
    v_mfma_f32_32x32x16_bf16 v[84:99], v[60:63], v[48:51], v[84:99]
    ds_read_b128 v[44:47], v22 offset:0
    ds_read_b128 v[48:51], v22 offset:4096
    ds_read_b64_tr_b16 v[60:61], v37 offset:10240
    ds_read_b64_tr_b16 v[62:63], v37 offset:11520
    s_waitcnt lgkmcnt(4)
    v_mfma_f32_32x32x16_bf16 v[68:83], v[64:67], v[52:55], v[68:83]
    v_mfma_f32_32x32x16_bf16 v[84:99], v[64:67], v[56:59], v[84:99]
    ds_read_b128 v[52:55], v23 offset:0
    ds_read_b128 v[56:59], v23 offset:4096
    ds_read_b64_tr_b16 v[64:65], v37 offset:15360
    ds_read_b64_tr_b16 v[66:67], v37 offset:16640
    s_waitcnt lgkmcnt(4)
    v_mfma_f32_32x32x16_bf16 v[68:83], v[60:63], v[44:47], v[68:83]
    v_mfma_f32_32x32x16_bf16 v[84:99], v[60:63], v[48:51], v[84:99]
    s_waitcnt lgkmcnt(0)
    v_mfma_f32_32x32x16_bf16 v[68:83], v[64:67], v[52:55], v[68:83]
    v_mfma_f32_32x32x16_bf16 v[84:99], v[64:67], v[56:59], v[84:99]
    s_waitcnt vmcnt(12)
    s_barrier
    ds_read_b128 v[44:47], v24 offset:0
    ds_read_b128 v[48:51], v24 offset:4096
    ds_read_b64_tr_b16 v[60:61], v38 offset:0
    ds_read_b64_tr_b16 v[62:63], v38 offset:1280
    ds_read_b128 v[52:55], v25 offset:0
    ds_read_b128 v[56:59], v25 offset:4096
    ds_read_b64_tr_b16 v[64:65], v38 offset:5120
    ds_read_b64_tr_b16 v[66:67], v38 offset:6400
    s_waitcnt lgkmcnt(4)
    v_mfma_f32_32x32x16_bf16 v[68:83], v[60:63], v[44:47], v[68:83]
    v_mfma_f32_32x32x16_bf16 v[84:99], v[60:63], v[48:51], v[84:99]
    ds_read_b128 v[44:47], v26 offset:0
    ds_read_b128 v[48:51], v26 offset:4096
    ds_read_b64_tr_b16 v[60:61], v38 offset:10240
    ds_read_b64_tr_b16 v[62:63], v38 offset:11520
    s_waitcnt lgkmcnt(4)
    v_mfma_f32_32x32x16_bf16 v[68:83], v[64:67], v[52:55], v[68:83]
    v_mfma_f32_32x32x16_bf16 v[84:99], v[64:67], v[56:59], v[84:99]
    ds_read_b128 v[52:55], v27 offset:0
    ds_read_b128 v[56:59], v27 offset:4096
    ds_read_b64_tr_b16 v[64:65], v38 offset:15360
    ds_read_b64_tr_b16 v[66:67], v38 offset:16640
    s_waitcnt lgkmcnt(4)
    v_mfma_f32_32x32x16_bf16 v[68:83], v[60:63], v[44:47], v[68:83]
    v_mfma_f32_32x32x16_bf16 v[84:99], v[60:63], v[48:51], v[84:99]
    s_waitcnt lgkmcnt(0)
    v_mfma_f32_32x32x16_bf16 v[68:83], v[64:67], v[52:55], v[68:83]
    v_mfma_f32_32x32x16_bf16 v[84:99], v[64:67], v[56:59], v[84:99]
    s_waitcnt vmcnt(6)
    s_barrier
    ds_read_b128 v[44:47], v28 offset:0
    ds_read_b128 v[48:51], v28 offset:4096
    ds_read_b64_tr_b16 v[60:61], v39 offset:0
    ds_read_b64_tr_b16 v[62:63], v39 offset:1280
    ds_read_b128 v[52:55], v29 offset:0
    ds_read_b128 v[56:59], v29 offset:4096
    ds_read_b64_tr_b16 v[64:65], v39 offset:5120
    ds_read_b64_tr_b16 v[66:67], v39 offset:6400
    s_waitcnt lgkmcnt(4)
    v_mfma_f32_32x32x16_bf16 v[68:83], v[60:63], v[44:47], v[68:83]
    v_mfma_f32_32x32x16_bf16 v[84:99], v[60:63], v[48:51], v[84:99]
    ds_read_b128 v[44:47], v30 offset:0
    ds_read_b128 v[48:51], v30 offset:4096
    ds_read_b64_tr_b16 v[60:61], v39 offset:10240
    ds_read_b64_tr_b16 v[62:63], v39 offset:11520
    s_waitcnt lgkmcnt(4)
    v_mfma_f32_32x32x16_bf16 v[68:83], v[64:67], v[52:55], v[68:83]
    v_mfma_f32_32x32x16_bf16 v[84:99], v[64:67], v[56:59], v[84:99]
    ds_read_b128 v[52:55], v31 offset:0
    ds_read_b128 v[56:59], v31 offset:4096
    ds_read_b64_tr_b16 v[64:65], v39 offset:15360
    ds_read_b64_tr_b16 v[66:67], v39 offset:16640
    s_waitcnt lgkmcnt(4)
    v_mfma_f32_32x32x16_bf16 v[68:83], v[60:63], v[44:47], v[68:83]
    v_mfma_f32_32x32x16_bf16 v[84:99], v[60:63], v[48:51], v[84:99]
    s_waitcnt lgkmcnt(0)
    v_mfma_f32_32x32x16_bf16 v[68:83], v[64:67], v[52:55], v[68:83]
    v_mfma_f32_32x32x16_bf16 v[84:99], v[64:67], v[56:59], v[84:99]
    s_waitcnt vmcnt(0)
    s_barrier
    ds_read_b128 v[44:47], v32 offset:0
    ds_read_b128 v[48:51], v32 offset:4096
    ds_read_b64_tr_b16 v[60:61], v40 offset:0
    ds_read_b64_tr_b16 v[62:63], v40 offset:1280
    ds_read_b128 v[52:55], v33 offset:0
    ds_read_b128 v[56:59], v33 offset:4096
    ds_read_b64_tr_b16 v[64:65], v40 offset:5120
    ds_read_b64_tr_b16 v[66:67], v40 offset:6400
    s_waitcnt lgkmcnt(4)
    v_mfma_f32_32x32x16_bf16 v[68:83], v[60:63], v[44:47], v[68:83]
    v_mfma_f32_32x32x16_bf16 v[84:99], v[60:63], v[48:51], v[84:99]
    ds_read_b128 v[44:47], v34 offset:0
    ds_read_b128 v[48:51], v34 offset:4096
    ds_read_b64_tr_b16 v[60:61], v40 offset:10240
    ds_read_b64_tr_b16 v[62:63], v40 offset:11520
    s_waitcnt lgkmcnt(4)
    v_mfma_f32_32x32x16_bf16 v[68:83], v[64:67], v[52:55], v[68:83]
    v_mfma_f32_32x32x16_bf16 v[84:99], v[64:67], v[56:59], v[84:99]
    ds_read_b128 v[52:55], v35 offset:0
    ds_read_b128 v[56:59], v35 offset:4096
    ds_read_b64_tr_b16 v[64:65], v40 offset:15360
    ds_read_b64_tr_b16 v[66:67], v40 offset:16640
    s_waitcnt lgkmcnt(4)
    v_mfma_f32_32x32x16_bf16 v[68:83], v[60:63], v[44:47], v[68:83]
    v_mfma_f32_32x32x16_bf16 v[84:99], v[60:63], v[48:51], v[84:99]
    s_waitcnt lgkmcnt(0)
    v_mfma_f32_32x32x16_bf16 v[68:83], v[64:67], v[52:55], v[68:83]
    v_mfma_f32_32x32x16_bf16 v[84:99], v[64:67], v[56:59], v[84:99]
    s_nop 15
    s_nop 15
    s_barrier
    v_and_b32 v3, 31, v2
    v_mul_u32_u24 v6, 336, v3
    v_lshrrev_b32 v7, 5, v2
    v_lshlrev_b32 v7, 3, v7
    s_lshl_b32 s31, s24, 6
    v_add3_u32 v6, v6, v7, s31
    v_cvt_pk_bf16_f32 v68, v68, v69
    v_cvt_pk_bf16_f32 v69, v70, v71
    ds_write_b64 v6, v[68:69] offset:0
    v_cvt_pk_bf16_f32 v72, v72, v73
    v_cvt_pk_bf16_f32 v73, v74, v75
    ds_write_b64 v6, v[72:73] offset:16
    v_cvt_pk_bf16_f32 v76, v76, v77
    v_cvt_pk_bf16_f32 v77, v78, v79
    ds_write_b64 v6, v[76:77] offset:32
    v_cvt_pk_bf16_f32 v80, v80, v81
    v_cvt_pk_bf16_f32 v81, v82, v83
    ds_write_b64 v6, v[80:81] offset:48
    v_cvt_pk_bf16_f32 v84, v84, v85
    v_cvt_pk_bf16_f32 v85, v86, v87
    ds_write_b64 v6, v[84:85] offset:10752
    v_cvt_pk_bf16_f32 v88, v88, v89
    v_cvt_pk_bf16_f32 v89, v90, v91
    ds_write_b64 v6, v[88:89] offset:10768
    v_cvt_pk_bf16_f32 v92, v92, v93
    v_cvt_pk_bf16_f32 v93, v94, v95
    ds_write_b64 v6, v[92:93] offset:10784
    v_cvt_pk_bf16_f32 v96, v96, v97
    v_cvt_pk_bf16_f32 v97, v98, v99
    ds_write_b64 v6, v[96:97] offset:10800
    s_waitcnt lgkmcnt(0)
    s_barrier
    s_lshl_b32 s31, s24, 8
    v_add_u32 v3, s31, v2
    s_lshl_b32 s32, s25, 6
    s_mul_i32 s34, s26, 320
    s_mul_i32 s35, s27, 1280
    s_add_u32 s34, s34, s35
    s_mov_b32 s35, 2560
    v_add_u32 v4, 0, v3
    v_mul_u32_u24 v5, s33, v4
    v_lshrrev_b32 v5, 16, v5
    v_mul_u32_u24 v6, 20, v5
    v_sub_u32 v6, v4, v6
    v_lshlrev_b32 v6, 4, v6
    v_mul_u32_u24 v7, 336, v5
    v_add_u32 v7, v7, v6
    ds_read_b128 v[68:71], v7
    v_add_u32 v5, s32, v5
    v_mad_u32_u24 v10, v5, s35, v6
    v_add_u32 v10, s34, v10
    v_add_u32 v4, 64, v3
    v_mul_u32_u24 v5, s33, v4
    v_lshrrev_b32 v5, 16, v5
    v_mul_u32_u24 v6, 20, v5
    v_sub_u32 v6, v4, v6
    v_lshlrev_b32 v6, 4, v6
    v_mul_u32_u24 v7, 336, v5
    v_add_u32 v7, v7, v6
    ds_read_b128 v[72:75], v7
    v_add_u32 v5, s32, v5
    v_mad_u32_u24 v11, v5, s35, v6
    v_add_u32 v11, s34, v11
    v_add_u32 v4, 128, v3
    v_mul_u32_u24 v5, s33, v4
    v_lshrrev_b32 v5, 16, v5
    v_mul_u32_u24 v6, 20, v5
    v_sub_u32 v6, v4, v6
    v_lshlrev_b32 v6, 4, v6
    v_mul_u32_u24 v7, 336, v5
    v_add_u32 v7, v7, v6
    ds_read_b128 v[76:79], v7
    v_add_u32 v5, s32, v5
    v_mad_u32_u24 v12, v5, s35, v6
    v_add_u32 v12, s34, v12
    v_add_u32 v4, 192, v3
    v_mul_u32_u24 v5, s33, v4
    v_lshrrev_b32 v5, 16, v5
    v_mul_u32_u24 v6, 20, v5
    v_sub_u32 v6, v4, v6
    v_lshlrev_b32 v6, 4, v6
    v_mul_u32_u24 v7, 336, v5
    v_add_u32 v7, v7, v6
    ds_read_b128 v[80:83], v7
    v_add_u32 v5, s32, v5
    v_mad_u32_u24 v13, v5, s35, v6
    v_add_u32 v13, s34, v13
    s_waitcnt lgkmcnt(3)
    buffer_store_dwordx4 v[68:71], v10, s[20:23], 0 offen
    s_waitcnt lgkmcnt(2)
    buffer_store_dwordx4 v[72:75], v11, s[20:23], 0 offen
    s_waitcnt lgkmcnt(1)
    buffer_store_dwordx4 v[76:79], v12, s[20:23], 0 offen
    s_waitcnt lgkmcnt(0)
    buffer_store_dwordx4 v[80:83], v13, s[20:23], 0 offen
oproj_kernel_done:
oproj_kernel_done2:
    s_endpgm

.section .rodata,"a"
.p2align 6
.amdhsa_kernel qkv_kernel
  .amdhsa_next_free_vgpr 128
  .amdhsa_next_free_sgpr 96
  .amdhsa_accum_offset 128
  .amdhsa_group_segment_fixed_size 0
  .amdhsa_kernarg_size 72
  .amdhsa_user_sgpr_count 2
  .amdhsa_user_sgpr_kernarg_segment_ptr 1
  .amdhsa_system_sgpr_workgroup_id_x 1
.end_amdhsa_kernel

.p2align 6
.amdhsa_kernel attn_kernel
  .amdhsa_next_free_vgpr 196
  .amdhsa_next_free_sgpr 96
  .amdhsa_accum_offset 196
  .amdhsa_group_segment_fixed_size 0
  .amdhsa_kernarg_size 72
  .amdhsa_user_sgpr_count 2
  .amdhsa_user_sgpr_kernarg_segment_ptr 1
  .amdhsa_system_sgpr_workgroup_id_x 1
.end_amdhsa_kernel

.p2align 6
.amdhsa_kernel oproj_kernel
  .amdhsa_next_free_vgpr 100
  .amdhsa_next_free_sgpr 96
  .amdhsa_accum_offset 100
  .amdhsa_group_segment_fixed_size 0
  .amdhsa_kernarg_size 72
  .amdhsa_user_sgpr_count 2
  .amdhsa_user_sgpr_kernarg_segment_ptr 1
  .amdhsa_system_sgpr_workgroup_id_x 1
.end_amdhsa_kernel
```
